```python
import torch

def _softmax(x, axis=-1):
    return torch.softmax(x, dim=axis)
def _gelu(x):
    return torch.nn.functional.gelu(x, approximate="tanh")
def _silu(x):
    return torch.nn.functional.silu(x)
def _sigmoid(x):
    return torch.sigmoid(x)
def _layernorm(x, axis=-1, eps=1e-5):
    m = x.mean(dim=axis, keepdim=True)
    v = x.var(dim=axis, keepdim=True, unbiased=False)
    return (x - m) / torch.sqrt(v + eps)
def _scatter_add(tgt, idx, src, axis=0):
    return tgt.clone().index_add_(axis, idx, src)
def _segment_sum(src, seg, n):
    out = torch.zeros((n,) + src.shape[1:], dtype=src.dtype)
    return out.index_add_(0, seg, src)
def _pad(x, pw):
    flat = tuple(v for pair in reversed(pw) for v in pair)
    return torch.nn.functional.pad(x, flat)

kernel_name = 'parallel_sum__ssm_conv_h3__moe_arch_mod__prompt'

def setup_inputs():

    _w = (lambda a: (lambda t: t.to(torch.bfloat16) if t.is_floating_point() else t)(torch.as_tensor(a)))
    def _A_setup():
        B, S, D = 1, 2048, 576
        ks = 4
        return {
            "q": _w((lambda *s: torch.randn(*s, dtype=torch.bfloat16) * 0.05)(B, S, D)),
            "k": _w((lambda *s: torch.randn(*s, dtype=torch.bfloat16) * 0.8)(B, S, D)),
            "v": _w((lambda *s: torch.randn(*s, dtype=torch.bfloat16) * 0.8)(B, S, D)),
            "shift_k": _w((lambda *s: torch.randn(*s, dtype=torch.bfloat16) * 0.8)(D, ks) * 0.5),
            "ssm_k": _w((lambda *s: torch.randn(*s, dtype=torch.bfloat16) * 0.8)(D, S) * (1.0 / S ** 0.5)),
            "ssm_D": _w((lambda *s: torch.randn(*s, dtype=torch.bfloat16) * 0.8)(D)),
        }
    _A_in = _A_setup()

    def _B_setup():
        B, S, D, F, C = 1, 2048, 576, 4608, 8
        return {
            "x": _w((lambda *s: torch.randn(*s, dtype=torch.bfloat16) * 0.05)(B, S, D)),
            "w_r": _w((lambda *s: torch.randn(*s, dtype=torch.bfloat16) * 0.05)(D)),
            "w_gate": _w((lambda *s: torch.randn(*s, dtype=torch.bfloat16) * 0.05)(D, F)),
            "w_up": _w((lambda *s: torch.randn(*s, dtype=torch.bfloat16) * 0.05)(D, F)),
            "w_down": _w((lambda *s: torch.randn(*s, dtype=torch.bfloat16) * 0.05)(F, D)),
        }
    _B_in = _B_setup()

    return {
        "A_q": _A_in["q"],
        "A_k": _A_in["k"],
        "A_v": _A_in["v"],
        "A_shift_k": _A_in["shift_k"],
        "A_ssm_k": _A_in["ssm_k"],
        "A_ssm_D": _A_in["ssm_D"],
        "B_x": _B_in["x"],
        "B_w_r": _B_in["w_r"],
        "B_w_gate": _B_in["w_gate"],
        "B_w_up": _B_in["w_up"],
        "B_w_down": _B_in["w_down"],
    }

def reference(A_q, A_k, A_v, A_shift_k, A_ssm_k, A_ssm_D, B_x, B_w_r, B_w_gate, B_w_up, B_w_down):
    def _A_ref(q, k, v, shift_k, ssm_k, ssm_D):
        B, S, D = q.shape
        ks = shift_k.shape[-1]
        k_pad = _pad(k, ((0, 0), (ks - 1, 0), (0, 0)))
        k_shift = torch.zeros_like(k)
        for t in range(ks):
            k_shift = k_shift + k_pad[:, t:t + S, :] * shift_k[:, ks - 1 - t][None, None, :]
        kv = k_shift * v
        L = 2 * S
        kv_pad = _pad(kv, ((0, 0), (0, S), (0, 0)))
        kf_pad = _pad(ssm_k, ((0, 0), (0, S)))
        kv_f = (lambda x, axes=(-2,-1): torch.fft.rfft2(x.float(), dim=axes))(kv_pad[:, None, :, :], axes=(1, 2))
        kf_f = (lambda x, axes=(-2,-1): torch.fft.rfft2(x.float(), dim=axes))(kf_pad[:, None, :], axes=(1, 2))
        kf_f = (lambda x, *d: x.permute(*d))(kf_f, 1, 2, 0)
        y_f = kv_f * kf_f[None, :, :, :]
        y = (lambda x, s, axes=(-2,-1): torch.fft.irfft2(x, s=s, dim=axes).to(torch.bfloat16))(y_f, (1, L), axes=(1, 2))[:, 0, :S, :]
        y = y + kv * ssm_D[None, None, :]
        return q * y

    def _B_ref(x, w_r, w_gate, w_up, w_down):
        B, S, D = x.shape
        C = 8
        r = x @ w_r
        idx = torch.argsort(-r, axis=-1)[:, :C]
        idx_e = (lambda x, n, axis: torch.repeat_interleave(x, n, dim=axis))(idx.reshape(B, C, 1), D, axis=2)
        x_sel = (lambda x, i, axis: torch.take_along_dim(x, i, dim=axis))(x, idx_e, axis=1)
        g = _silu(x_sel @ w_gate)
        u = x_sel @ w_up
        y = (g * u) @ w_down
        r_sel = _sigmoid((lambda x, i, axis: torch.take_along_dim(x, i, dim=axis))(r, idx, axis=1))
        y = y * r_sel.reshape(B, C, 1)
        b_off = (torch.arange(B) * S).reshape(B, 1)
        flat_idx = (idx + b_off).reshape(B * C)
        zero = (x * 0.0).reshape(B * S, D)
        upd = _scatter_add(zero, flat_idx, y.reshape(B * C, D), axis=0)
        return x + upd.reshape(B, S, D)

    x = A_q
    xn = _layernorm(x, axis=-1)
    return x + _A_ref(xn, A_k, A_v, A_shift_k, A_ssm_k, A_ssm_D) + _B_ref(xn, B_w_r, B_w_gate, B_w_up, B_w_down)
```

```asm
; @launch grid=(256,1,1) block=(512,1,1) lds=162208
.amdgcn_target "amdgcn-amd-amdhsa--gfx950"
.text
.globl parallel_sum__ssm_conv_h3__moe_arch_mod__prompt_kernel
.p2align 8
.type parallel_sum__ssm_conv_h3__moe_arch_mod__prompt_kernel,@function
parallel_sum__ssm_conv_h3__moe_arch_mod__prompt_kernel:
    s_cmp_ge_u32 s2, 256
    s_cbranch_scc1 L_end
    s_load_dwordx16 s[4:19], s[0:1], 0
    s_load_dwordx8 s[20:27], s[0:1], 64
    s_load_dwordx4 s[28:31], s[0:1], 96
    v_lshrrev_b32 v1, 6, v0
    v_and_b32 v0, 63, v0
    v_readfirstlane_b32 s3, v1
    s_mov_b32 s50, 0xffff0000
    s_mov_b32 s51, 0x05040100
    s_mov_b32 s52, 0x07060302
    s_waitcnt lgkmcnt(0)
    s_cmp_ge_u32 s2, 8
    s_cbranch_scc1 L_nw_1
    s_cmp_lg_u32 s3, 7
    s_cbranch_scc1 L_nw_1
    s_memrealtime s[54:55]
    s_waitcnt lgkmcnt(0)
    s_or_b32 s54, s54, 1
    v_mov_b32 v10, s54
    v_mov_b32 v11, 0
    v_mov_b32 v12, 0
    s_mov_b64 exec, 1
    global_atomic_cmpswap v12, v[10:11], s[28:29] sc1
    s_mov_b64 exec, -1
L_nw_1:
    s_cmp_lg_u32 s3, 6
    s_cbranch_scc1 L_cpf_2
    s_lshr_b32 s56, s2, 3
    s_cmp_ge_u32 s56, (L_end - parallel_sum__ssm_conv_h3__moe_arch_mod__prompt_kernel + 1023) / 1024
    s_cbranch_scc1 L_cpf_2
    s_getpc_b64 s[54:55]
L_cpf_2_pc:
    s_sub_u32 s54, s54, L_cpf_2_pc - parallel_sum__ssm_conv_h3__moe_arch_mod__prompt_kernel
    s_subb_u32 s55, s55, 0
    s_lshl_b32 s56, s56, 10
    v_lshlrev_b32 v1, 4, v0
    v_add_u32 v1, s56, v1
    global_load_dwordx4 a[60:63], v1, s[54:55]
L_cpf_2:
    s_cmp_ge_u32 s2, 144
    s_cbranch_scc1 L_moe
    s_sub_u32 s72, s3, 4
    s_mul_hi_u32 s77, s2, 477218589
    s_mul_i32 s76, s77, 9
    s_sub_u32 s76, s2, s76
    s_mov_b32 s32, s6
    s_and_b32 s33, s7, 0xffff
    s_mov_b32 s34, 2359296
    s_mov_b32 s35, 0x00020000
    s_mov_b32 s36, s8
    s_and_b32 s37, s9, 0xffff
    s_mov_b32 s38, 2359296
    s_mov_b32 s39, 0x00020000
    v_lshrrev_b32 v1, 3, v0
    v_and_b32 v2, 7, v0
    s_mul_i32 s56, s77, 147456
    s_lshl_b32 s57, s76, 7
    s_add_u32 s56, s56, s57
    v_mul_u32_u24 v3, 1152, v1
    v_lshl_add_u32 v3, v2, 4, v3
    v_add_u32 v3, s56, v3
    s_mul_i32 s58, s3, 18432
    s_mul_i32 s60, s3, 2080
    s_add_u32 s61, s60, 54224
    s_add_u32 s59, s58, 0
    s_mov_b32 m0, s61
    s_nop 0
    buffer_load_dwordx4 v3, s[32:35], s59 offen nt lds
    s_add_u32 s61, s60, 70864
    s_mov_b32 m0, s61
    s_nop 0
    buffer_load_dwordx4 v3, s[36:39], s59 offen nt lds
    s_add_u32 s61, s60, 55264
    s_add_u32 s59, s58, 9216
    s_mov_b32 m0, s61
    s_nop 0
    buffer_load_dwordx4 v3, s[32:35], s59 offen nt lds
    s_add_u32 s61, s60, 71904
    s_mov_b32 m0, s61
    s_nop 0
    buffer_load_dwordx4 v3, s[36:39], s59 offen nt lds
    s_cmp_lg_u32 s3, 7
    s_cbranch_scc1 L_w7_3
    v_subrev_u32 v4, 9216, v3
    s_cmp_lg_u32 s77, 0
    s_cbranch_scc1 L_w7_3_a
    v_bfrev_b32 v4, 1
L_w7_3_a:
    s_mov_b32 m0, 53184
    s_nop 0
    buffer_load_dwordx4 v4, s[32:35], 0 offen nt lds
    v_mov_b32 v52, 0
    v_mov_b32 v53, 0
    v_mov_b32 v54, 0
    v_mov_b32 v55, 0
    v_lshlrev_b32 v56, 4, v0
    v_add_u32 v56, 51328, v56
    s_mov_b64 exec, 0xfff
    ds_write_b128 v56, v[52:55]
    s_mov_b64 exec, -1
L_w7_3:
    s_lshr_b32 s63, s3, 1
    s_and_b32 s64, s3, 1
    s_cmp_lg_u32 s3, 0
    s_cbranch_scc1 L_tap_4
    s_mov_b32 s40, s10
    s_and_b32 s41, s11, 0xffff
    s_mov_b32 s42, 4608
    s_mov_b32 s43, 0x00020000
    s_lshl_b32 s65, s76, 9
    v_lshlrev_b32 v5, 4, v0
    s_mov_b64 exec, 0xffffffff
    s_mov_b32 m0, 52544
    s_nop 0
    buffer_load_dwordx4 v5, s[40:43], s65 offen  lds
    s_mov_b32 s40, s14
    s_and_b32 s41, s15, 0xffff
    s_mov_b32 s42, 1152
    s_mov_b32 s43, 0x00020000
    s_lshl_b32 s65, s76, 7
    v_lshlrev_b32 v5, 2, v0
    s_mov_b32 m0, 53056
    s_nop 0
    buffer_load_dword v5, s[40:43], s65 offen lds
    s_mov_b64 exec, -1
L_tap_4:
    v_mov_b32 v120, 0
    global_load_dword v121, v120, s[28:29] sc1
    s_and_b32 s67, s2, 7
    s_mul_i32 s67, s67, 18
    s_lshr_b32 s66, s2, 3
    s_add_u32 s67, s67, s66
    s_lshl_b32 s71, s67, 2
    s_and_b32 s66, s3, 3
    s_add_u32 s78, s71, s66
    s_lshl_b32 s79, s78, 12
    s_lshl_b32 s66, s64, 3
    v_add_u32 v6, s66, v2
    s_lshl_b32 s66, s63, 3
    v_add_u32 v7, s66, v1
    v_mul_u32_u24 v9, 1040, v6
    v_lshl_add_u32 v9, v7, 2, v9
    v_add_u32 v9, 53184, v9
    s_lshl_b32 s65, s76, 19
    s_lshl_b32 s66, s77, 9
    s_add_u32 s65, s65, s66
    s_lshl_b32 s66, s64, 8
    s_add_u32 s65, s65, s66
    v_lshlrev_b32 v8, 14, v7
    v_lshl_add_u32 v8, v2, 4, v8
    v_add_u32 v8, s65, v8
    s_barrier
    s_cmp_ge_u32 s3, 4
    s_cbranch_scc1 L_noh_5
    s_mov_b32 s40, s12
    s_and_b32 s41, s13, 0xffff
    s_mov_b32 s42, 2359296
    s_mov_b32 s43, 0x00020000
    v_lshlrev_b32 v4, 4, v0
    s_mul_i32 s74, s3, 4128
    s_add_u32 s63, s79, 0
    s_add_u32 s59, s74, 32
    s_mov_b32 m0, s59
    s_nop 0
    buffer_load_dwordx4 v4, s[40:43], s63 offen nt lds
    s_add_u32 s63, s79, 1024
    s_add_u32 s59, s74, 1056
    s_mov_b32 m0, s59
    s_nop 0
    buffer_load_dwordx4 v4, s[40:43], s63 offen nt lds
    s_add_u32 s63, s79, 2048
    s_add_u32 s59, s74, 2080
    s_mov_b32 m0, s59
    s_nop 0
    buffer_load_dwordx4 v4, s[40:43], s63 offen nt lds
    s_add_u32 s63, s79, 3072
    s_add_u32 s59, s74, 3104
    s_mov_b32 m0, s59
    s_nop 0
    buffer_load_dwordx4 v4, s[40:43], s63 offen nt lds
    s_waitcnt vmcnt(4) lgkmcnt(0)
    s_branch L_noh2_6
L_noh_5:
    s_and_b32 s55, s2, 7
    s_mul_i32 s55, s55, 1152
    s_lshr_b32 s56, s2, 3
    s_mul_i32 s56, s56, 28
    s_mul_i32 s57, s72, 7
    s_add_u32 s56, s56, s57
    s_add_u32 s56, s56, 72
    s_mul_i32 s56, s56, 9216
    s_add_u32 s55, s55, s56
    v_lshlrev_b32 v110, 4, v0
    v_add_u32 v110, s55, v110
    v_lshrrev_b32 v111, 3, v0
    v_mul_u32_u24 v111, 9216, v111
    v_and_b32 v112, 7, v0
    v_lshl_add_u32 v111, v112, 4, v111
    v_add_u32 v111, s55, v111
    v_add_u32 v111, 1024, v111
    v_mov_b32 v113, v110
    global_load_dwordx4 a[0:3], v113, s[20:21]
    v_add_u32 v113, 9216, v113
    global_load_dwordx4 a[0:3], v113, s[20:21]
    v_add_u32 v113, 9216, v113
    global_load_dwordx4 a[0:3], v113, s[20:21]
    v_add_u32 v113, 9216, v113
    global_load_dwordx4 a[0:3], v113, s[20:21]
    v_add_u32 v113, 9216, v113
    global_load_dwordx4 a[0:3], v113, s[20:21]
    v_add_u32 v113, 9216, v113
    global_load_dwordx4 a[0:3], v113, s[20:21]
    v_add_u32 v113, 9216, v113
    global_load_dwordx4 a[0:3], v113, s[20:21]
    s_mov_b32 exec_lo, 0xffffffff
    s_mov_b32 exec_hi, 0xffffff
    global_load_dwordx4 a[0:3], v111, s[20:21]
    s_mov_b64 exec, -1
    v_mov_b32 v113, v110
    global_load_dwordx4 a[0:3], v113, s[22:23]
    v_add_u32 v113, 9216, v113
    global_load_dwordx4 a[0:3], v113, s[22:23]
    v_add_u32 v113, 9216, v113
    global_load_dwordx4 a[0:3], v113, s[22:23]
    v_add_u32 v113, 9216, v113
    global_load_dwordx4 a[0:3], v113, s[22:23]
    v_add_u32 v113, 9216, v113
    global_load_dwordx4 a[0:3], v113, s[22:23]
    v_add_u32 v113, 9216, v113
    global_load_dwordx4 a[0:3], v113, s[22:23]
    v_add_u32 v113, 9216, v113
    global_load_dwordx4 a[0:3], v113, s[22:23]
    s_mov_b32 exec_lo, 0xffffffff
    s_mov_b32 exec_hi, 0xffffff
    global_load_dwordx4 a[0:3], v111, s[22:23]
    s_mov_b64 exec, -1
    s_waitcnt vmcnt(16) lgkmcnt(0)
L_noh2_6:
    v_readfirstlane_b32 s48, v121
    s_barrier
    ds_read_b32 v10, v9 offset:640
    ds_read_b32 v11, v9 offset:768
    ds_read_b32 v12, v9 offset:896
    ds_read_b32 v13, v9 offset:1040
    ds_read_b32 v14, v9 offset:1168
    ds_read_b32 v15, v9 offset:1296
    ds_read_b32 v16, v9 offset:1424
    ds_read_b32 v17, v9 offset:1552
    ds_read_b32 v18, v9 offset:1680
    ds_read_b32 v19, v9 offset:1808
    ds_read_b32 v20, v9 offset:1936
    v_lshlrev_b32 v5, 2, v7
    v_lshlrev_b32 v5, 2, v5
    v_add_u32 v5, 52544, v5
    ds_read_b128 v[48:51], v5
    ds_read_b32 v21, v9 offset:17680
    ds_read_b32 v22, v9 offset:17808
    ds_read_b32 v23, v9 offset:17936
    ds_read_b32 v24, v9 offset:18064
    ds_read_b32 v25, v9 offset:18192
    ds_read_b32 v26, v9 offset:18320
    ds_read_b32 v27, v9 offset:18448
    ds_read_b32 v28, v9 offset:18576
    s_waitcnt lgkmcnt(8)
    s_cmp_lg_u32 s48, 0
    s_cbranch_scc1 L_hasn_7
    v_mov_b32 v30, 0
    s_mov_b32 s54, 0
L_nonce_8:
    global_load_dword v31, v30, s[28:29] sc1
    s_waitcnt vmcnt(0)
    v_readfirstlane_b32 s48, v31
    s_add_u32 s54, s54, 1
    s_cmp_lg_u32 s48, 0
    s_cbranch_scc1 L_nonced_9
    s_cmp_lt_u32 s54, 400000
    s_cbranch_scc1 L_nonce_8
L_nonced_9:
L_hasn_7:
    v_lshlrev_b32 v52, 16, v48
    v_lshlrev_b32 v53, 16, v50
    v_and_b32 v54, s50, v48
    v_and_b32 v55, s50, v50
    v_lshlrev_b32 v56, 16, v49
    v_lshlrev_b32 v57, 16, v51
    v_and_b32 v58, s50, v49
    v_and_b32 v59, s50, v51
    v_lshlrev_b32 v80, 16, v10
    v_and_b32 v81, s50, v10
    v_lshlrev_b32 v82, 16, v11
    v_and_b32 v83, s50, v11
    v_lshlrev_b32 v84, 16, v12
    v_and_b32 v85, s50, v12
    v_lshlrev_b32 v86, 16, v13
    v_and_b32 v87, s50, v13
    v_lshlrev_b32 v88, 16, v14
    v_and_b32 v89, s50, v14
    v_lshlrev_b32 v90, 16, v15
    v_and_b32 v91, s50, v15
    v_lshlrev_b32 v92, 16, v16
    v_and_b32 v93, s50, v16
    v_lshlrev_b32 v94, 16, v17
    v_and_b32 v95, s50, v17
    v_lshlrev_b32 v96, 16, v18
    v_and_b32 v97, s50, v18
    v_lshlrev_b32 v98, 16, v19
    v_and_b32 v99, s50, v19
    v_lshlrev_b32 v100, 16, v20
    v_and_b32 v101, s50, v20
    v_pk_mul_f32 v[102:103], v[80:81], v[58:59]
    v_pk_mul_f32 v[104:105], v[82:83], v[58:59]
    v_pk_mul_f32 v[106:107], v[84:85], v[58:59]
    v_pk_mul_f32 v[108:109], v[86:87], v[58:59]
    v_pk_mul_f32 v[110:111], v[88:89], v[58:59]
    v_pk_mul_f32 v[112:113], v[90:91], v[58:59]
    v_pk_mul_f32 v[114:115], v[92:93], v[58:59]
    v_pk_mul_f32 v[116:117], v[94:95], v[58:59]
    v_pk_fma_f32 v[102:103], v[82:83], v[56:57], v[102:103]
    v_pk_fma_f32 v[104:105], v[84:85], v[56:57], v[104:105]
    v_pk_fma_f32 v[106:107], v[86:87], v[56:57], v[106:107]
    v_pk_fma_f32 v[108:109], v[88:89], v[56:57], v[108:109]
    v_pk_fma_f32 v[110:111], v[90:91], v[56:57], v[110:111]
    v_pk_fma_f32 v[112:113], v[92:93], v[56:57], v[112:113]
    v_pk_fma_f32 v[114:115], v[94:95], v[56:57], v[114:115]
    v_pk_fma_f32 v[116:117], v[96:97], v[56:57], v[116:117]
    v_pk_fma_f32 v[102:103], v[84:85], v[54:55], v[102:103]
    v_pk_fma_f32 v[104:105], v[86:87], v[54:55], v[104:105]
    v_pk_fma_f32 v[106:107], v[88:89], v[54:55], v[106:107]
    v_pk_fma_f32 v[108:109], v[90:91], v[54:55], v[108:109]
    v_pk_fma_f32 v[110:111], v[92:93], v[54:55], v[110:111]
    v_pk_fma_f32 v[112:113], v[94:95], v[54:55], v[112:113]
    v_pk_fma_f32 v[114:115], v[96:97], v[54:55], v[114:115]
    v_pk_fma_f32 v[116:117], v[98:99], v[54:55], v[116:117]
    v_pk_fma_f32 v[102:103], v[86:87], v[52:53], v[102:103]
    v_pk_fma_f32 v[104:105], v[88:89], v[52:53], v[104:105]
    v_pk_fma_f32 v[106:107], v[90:91], v[52:53], v[106:107]
    v_pk_fma_f32 v[108:109], v[92:93], v[52:53], v[108:109]
    v_pk_fma_f32 v[110:111], v[94:95], v[52:53], v[110:111]
    v_pk_fma_f32 v[112:113], v[96:97], v[52:53], v[112:113]
    v_pk_fma_f32 v[114:115], v[98:99], v[52:53], v[114:115]
    v_pk_fma_f32 v[116:117], v[100:101], v[52:53], v[116:117]
    s_waitcnt lgkmcnt(0)
    v_lshlrev_b32 v60, 16, v21
    v_and_b32 v61, s50, v21
    v_lshlrev_b32 v62, 16, v22
    v_and_b32 v63, s50, v22
    v_lshlrev_b32 v64, 16, v23
    v_and_b32 v65, s50, v23
    v_lshlrev_b32 v66, 16, v24
    v_and_b32 v67, s50, v24
    v_lshlrev_b32 v68, 16, v25
    v_and_b32 v69, s50, v25
    v_lshlrev_b32 v70, 16, v26
    v_and_b32 v71, s50, v26
    v_lshlrev_b32 v72, 16, v27
    v_and_b32 v73, s50, v27
    v_lshlrev_b32 v74, 16, v28
    v_and_b32 v75, s50, v28
    v_pk_mul_f32 v[102:103], v[102:103], v[60:61]
    v_pk_mul_f32 v[104:105], v[104:105], v[62:63]
    v_pk_mul_f32 v[106:107], v[106:107], v[64:65]
    v_pk_mul_f32 v[108:109], v[108:109], v[66:67]
    v_pk_mul_f32 v[110:111], v[110:111], v[68:69]
    v_pk_mul_f32 v[112:113], v[112:113], v[70:71]
    v_pk_mul_f32 v[114:115], v[114:115], v[72:73]
    v_pk_mul_f32 v[116:117], v[116:117], v[74:75]
    v_cvt_pk_bf16_f32 v80, v102, v104
    v_mov_b32 v81, s48
    v_cvt_pk_bf16_f32 v82, v106, v108
    v_mov_b32 v83, s48
    v_cvt_pk_bf16_f32 v84, v110, v112
    v_mov_b32 v85, s48
    v_cvt_pk_bf16_f32 v86, v114, v116
    v_mov_b32 v87, s48
    v_cvt_pk_bf16_f32 v88, v103, v105
    v_mov_b32 v89, s48
    v_cvt_pk_bf16_f32 v90, v107, v109
    v_mov_b32 v91, s48
    v_cvt_pk_bf16_f32 v92, v111, v113
    v_mov_b32 v93, s48
    v_cvt_pk_bf16_f32 v94, v115, v117
    v_mov_b32 v95, s48
    s_add_u32 s56, s30, 0
    s_addc_u32 s57, s31, 0
    s_add_u32 s62, s30, 8192
    s_addc_u32 s63, s31, 0
    global_store_dwordx4 v8, v[80:83], s[56:57] sc1
    global_store_dwordx4 v8, v[84:87], s[56:57] offset:128 sc1
    global_store_dwordx4 v8, v[88:91], s[62:63] sc1
    global_store_dwordx4 v8, v[92:95], s[62:63] offset:128 sc1
    v_mov_b32 v120, v80
    v_mov_b32 v121, v82
    v_mov_b32 v122, v84
    v_mov_b32 v123, v86
    v_mov_b32 v124, v88
    v_mov_b32 v125, v90
    v_mov_b32 v126, v92
    v_mov_b32 v127, v94
    s_lshl_b32 s55, s3, 11
    v_lshlrev_b32 v4, 5, v0
    v_add_u32 v4, s55, v4
    v_add_u32 v4, 34944, v4
    ds_write_b128 v4, v[120:123]
    ds_write_b128 v4, v[124:127] offset:16
    s_waitcnt lgkmcnt(0)
    s_barrier
    s_cmp_ge_u32 s3, 4
    s_cbranch_scc1 L_helper
    s_mul_i32 s75, s3, 4608
    s_add_u32 s75, s75, 16512
    v_mov_b32 v16, 0
    v_mov_b32 v17, 0
    v_mov_b32 v18, 0
    v_mov_b32 v19, 0
    v_lshlrev_b32 v2, 4, v0
    v_add_u32 v2, s74, v2
    s_mov_b64 exec, 3
    ds_write_b128 v2, v[16:19]
    s_mov_b64 exec, -1
    v_lshrrev_b32 v2, 3, v0
    v_mul_u32_u24 v2, 1152, v2
    v_and_b32 v3, 7, v0
    v_lshl_add_u32 v2, v3, 4, v2
    v_add_u32 v2, s75, v2
    s_mov_b64 exec, 0xffffffff
    ds_write_b128 v2, v[16:19]
    s_mov_b64 exec, -1
    v_and_b32 v3, 3, v0
    v_bfe_u32 v4, v0, 2, 2
    v_sub_u32 v3, v3, v4
    v_lshlrev_b32 v3, 3, v3
    v_lshrrev_b32 v4, 4, v0
    v_lshl_add_u32 v3, v4, 6, v3
    v_add_u32 v3, s74, v3
    v_add_u32 v3, 32, v3
    s_waitcnt vmcnt(4) lgkmcnt(0)
    ds_read_b64_tr_b16 a[0:1], v3 offset:32
    ds_read_b64_tr_b16 a[2:3], v3 offset:0
    ds_read_b64_tr_b16 a[32:33], v3 offset:288
    ds_read_b64_tr_b16 a[34:35], v3 offset:256
    ds_read_b64_tr_b16 a[4:5], v3 offset:544
    ds_read_b64_tr_b16 a[6:7], v3 offset:512
    ds_read_b64_tr_b16 a[36:37], v3 offset:800
    ds_read_b64_tr_b16 a[38:39], v3 offset:768
    ds_read_b64_tr_b16 a[8:9], v3 offset:1056
    ds_read_b64_tr_b16 a[10:11], v3 offset:1024
    ds_read_b64_tr_b16 a[40:41], v3 offset:1312
    ds_read_b64_tr_b16 a[42:43], v3 offset:1280
    s_waitcnt lgkmcnt(4)
    ds_read_b64_tr_b16 a[12:13], v3 offset:1568
    ds_read_b64_tr_b16 a[14:15], v3 offset:1536
    ds_read_b64_tr_b16 a[44:45], v3 offset:1824
    ds_read_b64_tr_b16 a[46:47], v3 offset:1792
    ds_read_b64_tr_b16 a[16:17], v3 offset:2080
    ds_read_b64_tr_b16 a[18:19], v3 offset:2048
    ds_read_b64_tr_b16 a[48:49], v3 offset:2336
    ds_read_b64_tr_b16 a[50:51], v3 offset:2304
    ds_read_b64_tr_b16 a[20:21], v3 offset:2592
    ds_read_b64_tr_b16 a[22:23], v3 offset:2560
    ds_read_b64_tr_b16 a[52:53], v3 offset:2848
    ds_read_b64_tr_b16 a[54:55], v3 offset:2816
    s_waitcnt lgkmcnt(4)
    ds_read_b64_tr_b16 a[24:25], v3 offset:3104
    ds_read_b64_tr_b16 a[26:27], v3 offset:3072
    ds_read_b64_tr_b16 a[56:57], v3 offset:3360
    ds_read_b64_tr_b16 a[58:59], v3 offset:3328
    ds_read_b64_tr_b16 a[28:29], v3 offset:3616
    ds_read_b64_tr_b16 a[30:31], v3 offset:3584
    ds_read_b64_tr_b16 a[60:61], v3 offset:3872
    ds_read_b64_tr_b16 a[62:63], v3 offset:3840
    v_and_b32 v5, 15, v0
    v_lshlrev_b32 v6, 3, v5
    v_lshlrev_b32 v7, 4, v4
    v_sub_u32 v6, v6, v7
    v_add_u32 v6, s75, v6
    v_add_u32 v6, 56, v6
    v_lshlrev_b32 v7, 6, v5
    v_lshl_add_u32 v7, v4, 4, v7
    s_lshl_b32 s55, s78, 13
    v_add_u32 v7, s55, v7
    v_add_u32 v11, 4096, v7
    s_add_u32 s62, s30, 16777216
    s_addc_u32 s63, s31, 0
    v_subrev_u32 v8, 16, v0
    v_add_u32 v9, 47, v0
    v_cmp_gt_u32 vcc, 16, v0
    s_nop 1
    v_cndmask_b32 v8, v8, v9, vcc
    v_mov_b32 v9, 63
    v_cmp_eq_u32 vcc, 0, v0
    s_nop 1
    v_cndmask_b32 v8, v8, v9, vcc
    v_lshlrev_b32 v8, 2, v8
    v_mov_b32 v9, 51328
    v_mov_b32 v10, 1
    s_mov_b64 s[66:67], 1
    s_add_u32 s64, s30, 0
    s_addc_u32 s65, s31, 0
    s_lshl_b32 s55, s78, 13
    v_lshlrev_b32 v1, 4, v0
    v_add_u32 v1, s55, v1
    v_add_u32 v12, 4096, v1
    v_lshrrev_b32 v2, 4, v0
    v_lshlrev_b32 v2, 4, v2
    v_and_b32 v13, 7, v0
    v_lshl_add_u32 v2, v13, 1, v2
    v_bfe_u32 v13, v0, 3, 1
    v_add_u32 v2, v2, v13
    v_lshlrev_b32 v2, 1, v2
    v_add_u32 v2, s75, v2
    v_and_b32 v13, 15, v0
    v_lshlrev_b32 v13, 9, v13
    v_add_u32 v13, s55, v13
    v_add_u32 v13, 504, v13
    s_mov_b32 s54, 0
L_pl_11:
    global_load_dwordx2 v[14:15], v13, s[64:65] sc1
    s_waitcnt vmcnt(0)
    v_xor_b32 v16, s48, v15
    v_cmp_ne_u32 vcc, 0, v16
    s_add_u32 s54, s54, 1
    s_nop 3
    s_cmp_eq_u64 vcc, 0
    s_cbranch_scc1 L_pld_12
    s_sleep 1
    s_cmp_lt_u32 s54, 400000
    s_cbranch_scc1 L_pl_11
L_pld_12:
    s_mov_b32 s54, 0
L_pl_13:
    global_load_dwordx4 v[16:19], v1, s[64:65] offset:0 sc1
    global_load_dwordx4 v[20:23], v1, s[64:65] offset:1024 sc1
    global_load_dwordx4 v[24:27], v1, s[64:65] offset:2048 sc1
    global_load_dwordx4 v[28:31], v1, s[64:65] offset:3072 sc1
    global_load_dwordx4 v[32:35], v12, s[64:65] offset:0 sc1
    global_load_dwordx4 v[36:39], v12, s[64:65] offset:1024 sc1
    global_load_dwordx4 v[40:43], v12, s[64:65] offset:2048 sc1
    global_load_dwordx4 v[44:47], v12, s[64:65] offset:3072 sc1
    s_waitcnt vmcnt(0)
    v_xor_b32 v14, s48, v17
    v_xor_b32 v48, s48, v19
    v_xor_b32 v49, s48, v21
    v_or3_b32 v14, v14, v48, v49
    v_xor_b32 v48, s48, v23
    v_xor_b32 v49, s48, v25
    v_or3_b32 v14, v14, v48, v49
    v_xor_b32 v48, s48, v27
    v_xor_b32 v49, s48, v29
    v_or3_b32 v14, v14, v48, v49
    v_xor_b32 v48, s48, v31
    v_xor_b32 v49, s48, v33
    v_or3_b32 v14, v14, v48, v49
    v_xor_b32 v48, s48, v35
    v_xor_b32 v49, s48, v37
    v_or3_b32 v14, v14, v48, v49
    v_xor_b32 v48, s48, v39
    v_xor_b32 v49, s48, v41
    v_or3_b32 v14, v14, v48, v49
    v_xor_b32 v48, s48, v43
    v_xor_b32 v49, s48, v45
    v_or3_b32 v14, v14, v48, v49
    v_xor_b32 v48, s48, v47
    v_or_b32 v14, v14, v48
    v_cmp_ne_u32 vcc, 0, v14
    s_add_u32 s54, s54, 1
    s_nop 3
    s_cmp_eq_u64 vcc, 0
    s_cbranch_scc1 L_pld_14
    s_sleep 1
    s_cmp_lt_u32 s54, 400000
    s_cbranch_scc1 L_pl_13
L_pld_14:
L_kvok_10:
    ds_write_b16 v2, v16 offset:128
    ds_write_b16_d16_hi v2, v16 offset:1280
    ds_write_b16 v2, v18 offset:2432
    ds_write_b16_d16_hi v2, v18 offset:3584
    ds_write_b16 v2, v20 offset:256
    ds_write_b16_d16_hi v2, v20 offset:1408
    ds_write_b16 v2, v22 offset:2560
    ds_write_b16_d16_hi v2, v22 offset:3712
    ds_write_b16 v2, v24 offset:384
    ds_write_b16_d16_hi v2, v24 offset:1536
    ds_write_b16 v2, v26 offset:2688
    ds_write_b16_d16_hi v2, v26 offset:3840
    ds_write_b16 v2, v28 offset:512
    ds_write_b16_d16_hi v2, v28 offset:1664
    ds_write_b16 v2, v30 offset:2816
    ds_write_b16_d16_hi v2, v30 offset:3968
    ds_write_b16 v2, v32 offset:640
    ds_write_b16_d16_hi v2, v32 offset:1792
    ds_write_b16 v2, v34 offset:2944
    ds_write_b16_d16_hi v2, v34 offset:4096
    ds_write_b16 v2, v36 offset:768
    ds_write_b16_d16_hi v2, v36 offset:1920
    ds_write_b16 v2, v38 offset:3072
    ds_write_b16_d16_hi v2, v38 offset:4224
    ds_write_b16 v2, v40 offset:896
    ds_write_b16_d16_hi v2, v40 offset:2048
    ds_write_b16 v2, v42 offset:3200
    ds_write_b16_d16_hi v2, v42 offset:4352
    ds_write_b16 v2, v44 offset:1024
    ds_write_b16_d16_hi v2, v44 offset:2176
    ds_write_b16 v2, v46 offset:3328
    ds_write_b16_d16_hi v2, v46 offset:4480
    s_waitcnt lgkmcnt(0)
    v_mov_b32 v40, 0
    v_mov_b32 v41, 0
    v_mov_b32 v42, 0
    v_add_u32 v3, 1152, v6
    v_add_u32 v4, 2304, v6
    v_add_u32 v5, 3456, v6
    v_mov_b32 v45, s48
    v_mov_b32 v47, s48
    ds_read2_b64 v[48:51], v6 offset0:8 offset1:9
    ds_read2_b64 v[52:55], v6 offset0:0 offset1:1
    ds_read2_b64 v[56:59], v3 offset0:8 offset1:9
    s_waitcnt lgkmcnt(2)
    v_mfma_f32_16x16x32_bf16 v[64:67], a[0:3], v[48:51], 0
    ds_read2_b64 v[60:63], v3 offset0:0 offset1:1
    v_mfma_f32_16x16x32_bf16 v[68:71], a[4:7], v[48:51], 0
    v_mfma_f32_16x16x32_bf16 v[72:75], a[8:11], v[48:51], 0
    v_mfma_f32_16x16x32_bf16 v[76:79], a[12:15], v[48:51], 0
    v_mfma_f32_16x16x32_bf16 v[80:83], a[16:19], v[48:51], 0
    v_mfma_f32_16x16x32_bf16 v[84:87], a[20:23], v[48:51], 0
    v_mfma_f32_16x16x32_bf16 v[88:91], a[24:27], v[48:51], 0
    v_mfma_f32_16x16x32_bf16 v[92:95], a[28:31], v[48:51], 0
    s_waitcnt lgkmcnt(2)
    v_mfma_f32_16x16x32_bf16 v[64:67], a[32:35], v[52:55], v[64:67]
    ds_read2_b64 v[48:51], v4 offset0:8 offset1:9
    v_mfma_f32_16x16x32_bf16 v[68:71], a[36:39], v[52:55], v[68:71]
    v_mfma_f32_16x16x32_bf16 v[72:75], a[40:43], v[52:55], v[72:75]
    v_mfma_f32_16x16x32_bf16 v[76:79], a[44:47], v[52:55], v[76:79]
    v_mfma_f32_16x16x32_bf16 v[80:83], a[48:51], v[52:55], v[80:83]
    v_mfma_f32_16x16x32_bf16 v[84:87], a[52:55], v[52:55], v[84:87]
    v_mfma_f32_16x16x32_bf16 v[88:91], a[56:59], v[52:55], v[88:91]
    v_mfma_f32_16x16x32_bf16 v[92:95], a[60:63], v[52:55], v[92:95]
    s_waitcnt lgkmcnt(2)
    v_mfma_f32_16x16x32_bf16 v[96:99], a[0:3], v[56:59], 0
    ds_read2_b64 v[52:55], v4 offset0:0 offset1:1
    v_mfma_f32_16x16x32_bf16 v[100:103], a[4:7], v[56:59], 0
    v_mfma_f32_16x16x32_bf16 v[104:107], a[8:11], v[56:59], 0
    v_mfma_f32_16x16x32_bf16 v[108:111], a[12:15], v[56:59], 0
    v_mfma_f32_16x16x32_bf16 v[112:115], a[16:19], v[56:59], 0
    v_mfma_f32_16x16x32_bf16 v[116:119], a[20:23], v[56:59], 0
    v_mfma_f32_16x16x32_bf16 v[120:123], a[24:27], v[56:59], 0
    v_mfma_f32_16x16x32_bf16 v[124:127], a[28:31], v[56:59], 0
    s_waitcnt lgkmcnt(2)
    v_mfma_f32_16x16x32_bf16 v[96:99], a[32:35], v[60:63], v[96:99]
    ds_read2_b64 v[56:59], v5 offset0:8 offset1:9
    v_mfma_f32_16x16x32_bf16 v[100:103], a[36:39], v[60:63], v[100:103]
    v_mfma_f32_16x16x32_bf16 v[104:107], a[40:43], v[60:63], v[104:107]
    v_mfma_f32_16x16x32_bf16 v[108:111], a[44:47], v[60:63], v[108:111]
    v_mfma_f32_16x16x32_bf16 v[112:115], a[48:51], v[60:63], v[112:115]
    v_mfma_f32_16x16x32_bf16 v[116:119], a[52:55], v[60:63], v[116:119]
    v_mfma_f32_16x16x32_bf16 v[120:123], a[56:59], v[60:63], v[120:123]
    v_mfma_f32_16x16x32_bf16 v[124:127], a[60:63], v[60:63], v[124:127]
    s_waitcnt lgkmcnt(2)
    v_mfma_f32_16x16x32_bf16 v[128:131], a[0:3], v[48:51], 0
    ds_read2_b64 v[60:63], v5 offset0:0 offset1:1
    v_mfma_f32_16x16x32_bf16 v[132:135], a[4:7], v[48:51], 0
    v_mfma_f32_16x16x32_bf16 v[136:139], a[8:11], v[48:51], 0
    v_mfma_f32_16x16x32_bf16 v[140:143], a[12:15], v[48:51], 0
    v_mfma_f32_16x16x32_bf16 v[144:147], a[16:19], v[48:51], 0
    v_mfma_f32_16x16x32_bf16 v[148:151], a[20:23], v[48:51], 0
    v_mfma_f32_16x16x32_bf16 v[152:155], a[24:27], v[48:51], 0
    v_mfma_f32_16x16x32_bf16 v[156:159], a[28:31], v[48:51], 0
    s_waitcnt lgkmcnt(2)
    v_mfma_f32_16x16x32_bf16 v[128:131], a[32:35], v[52:55], v[128:131]
    ds_read2_b64 v[48:51], v6 offset0:24 offset1:25
    v_mfma_f32_16x16x32_bf16 v[132:135], a[36:39], v[52:55], v[132:135]
    v_mfma_f32_16x16x32_bf16 v[136:139], a[40:43], v[52:55], v[136:139]
    v_mfma_f32_16x16x32_bf16 v[140:143], a[44:47], v[52:55], v[140:143]
    v_mfma_f32_16x16x32_bf16 v[144:147], a[48:51], v[52:55], v[144:147]
    v_mfma_f32_16x16x32_bf16 v[148:151], a[52:55], v[52:55], v[148:151]
    v_mfma_f32_16x16x32_bf16 v[152:155], a[56:59], v[52:55], v[152:155]
    v_mfma_f32_16x16x32_bf16 v[156:159], a[60:63], v[52:55], v[156:159]
    s_waitcnt lgkmcnt(2)
    v_mfma_f32_16x16x32_bf16 v[160:163], a[0:3], v[56:59], 0
    ds_read2_b64 v[52:55], v6 offset0:16 offset1:17
    v_mfma_f32_16x16x32_bf16 v[164:167], a[4:7], v[56:59], 0
    v_mfma_f32_16x16x32_bf16 v[168:171], a[8:11], v[56:59], 0
    v_mfma_f32_16x16x32_bf16 v[172:175], a[12:15], v[56:59], 0
    v_mfma_f32_16x16x32_bf16 v[176:179], a[16:19], v[56:59], 0
    v_mfma_f32_16x16x32_bf16 v[180:183], a[20:23], v[56:59], 0
    v_mfma_f32_16x16x32_bf16 v[184:187], a[24:27], v[56:59], 0
    v_mfma_f32_16x16x32_bf16 v[188:191], a[28:31], v[56:59], 0
    s_waitcnt lgkmcnt(2)
    v_mfma_f32_16x16x32_bf16 v[160:163], a[32:35], v[60:63], v[160:163]
    ds_read2_b64 v[56:59], v3 offset0:24 offset1:25
    v_mfma_f32_16x16x32_bf16 v[164:167], a[36:39], v[60:63], v[164:167]
    v_mfma_f32_16x16x32_bf16 v[168:171], a[40:43], v[60:63], v[168:171]
    v_mfma_f32_16x16x32_bf16 v[172:175], a[44:47], v[60:63], v[172:175]
    v_mfma_f32_16x16x32_bf16 v[176:179], a[48:51], v[60:63], v[176:179]
    v_mfma_f32_16x16x32_bf16 v[180:183], a[52:55], v[60:63], v[180:183]
    v_mfma_f32_16x16x32_bf16 v[184:187], a[56:59], v[60:63], v[184:187]
    v_mfma_f32_16x16x32_bf16 v[188:191], a[60:63], v[60:63], v[188:191]
    s_waitcnt lgkmcnt(2)
    v_mfma_f32_16x16x32_bf16 v[68:71], a[0:3], v[48:51], v[68:71]
    ds_read2_b64 v[60:63], v3 offset0:16 offset1:17
    v_mfma_f32_16x16x32_bf16 v[72:75], a[4:7], v[48:51], v[72:75]
    ds_read2_b64 a[28:31], v4 offset0:24 offset1:25
    v_mfma_f32_16x16x32_bf16 v[76:79], a[8:11], v[48:51], v[76:79]
    v_add_f32 v65, v65, v96
    v_mfma_f32_16x16x32_bf16 v[80:83], a[12:15], v[48:51], v[80:83]
    v_add_f32 v66, v66, v97
    v_mfma_f32_16x16x32_bf16 v[84:87], a[16:19], v[48:51], v[84:87]
    v_add_f32 v67, v67, v98
    v_mfma_f32_16x16x32_bf16 v[88:91], a[20:23], v[48:51], v[88:91]
    v_add_f32 v32, v99, v130
    v_mfma_f32_16x16x32_bf16 v[92:95], a[24:27], v[48:51], v[92:95]
    v_add_f32 v66, v66, v128
    s_waitcnt lgkmcnt(3)
    v_mfma_f32_16x16x32_bf16 v[68:71], a[32:35], v[52:55], v[68:71]
    v_add_f32 v67, v67, v129
    v_mfma_f32_16x16x32_bf16 v[72:75], a[36:39], v[52:55], v[72:75]
    v_add_f32 v33, v131, v162
    v_mfma_f32_16x16x32_bf16 v[76:79], a[40:43], v[52:55], v[76:79]
    v_add_f32 v32, v32, v161
    v_mfma_f32_16x16x32_bf16 v[80:83], a[44:47], v[52:55], v[80:83]
    ds_bpermute_b32 v38, v8, v163
    v_mfma_f32_16x16x32_bf16 v[84:87], a[48:51], v[52:55], v[84:87]
    ds_bpermute_b32 v37, v8, v33
    v_mfma_f32_16x16x32_bf16 v[88:91], a[52:55], v[52:55], v[88:91]
    ds_bpermute_b32 v36, v8, v32
    v_mfma_f32_16x16x32_bf16 v[92:95], a[56:59], v[52:55], v[92:95]
    v_add_f32 v67, v67, v160
    s_waitcnt lgkmcnt(5)
    v_mfma_f32_16x16x32_bf16 v[100:103], a[0:3], v[56:59], v[100:103]
    s_waitcnt lgkmcnt(0)
    v_mfma_f32_16x16x32_bf16 v[104:107], a[4:7], v[56:59], v[104:107]
    v_cndmask_b32 v28, v36, v40, s[66:67]
    v_mfma_f32_16x16x32_bf16 v[108:111], a[8:11], v[56:59], v[108:111]
    v_cndmask_b32 v29, v37, v41, s[66:67]
    v_mfma_f32_16x16x32_bf16 v[112:115], a[12:15], v[56:59], v[112:115]
    v_cndmask_b32 v30, v38, v42, s[66:67]
    v_mfma_f32_16x16x32_bf16 v[116:119], a[16:19], v[56:59], v[116:119]
    v_add_f32 v64, v64, v28
    v_mfma_f32_16x16x32_bf16 v[120:123], a[20:23], v[56:59], v[120:123]
    v_add_f32 v65, v65, v29
    v_mfma_f32_16x16x32_bf16 v[124:127], a[24:27], v[56:59], v[124:127]
    v_add_f32 v66, v66, v30
    v_mfma_f32_16x16x32_bf16 v[100:103], a[32:35], v[60:63], v[100:103]
    ds_read2_b64 a[60:63], v4 offset0:16 offset1:17
    v_mfma_f32_16x16x32_bf16 v[104:107], a[36:39], v[60:63], v[104:107]
    v_cvt_pk_bf16_f32 v44, v64, v65
    v_mfma_f32_16x16x32_bf16 v[108:111], a[40:43], v[60:63], v[108:111]
    v_cvt_pk_bf16_f32 v46, v66, v67
    v_mfma_f32_16x16x32_bf16 v[112:115], a[44:47], v[60:63], v[112:115]
    global_store_dwordx4 v7, v[44:47], s[62:63] offset:0 sc1
    v_mfma_f32_16x16x32_bf16 v[116:119], a[48:51], v[60:63], v[116:119]
    ds_read2_b64 v[48:51], v5 offset0:24 offset1:25
    v_mfma_f32_16x16x32_bf16 v[120:123], a[52:55], v[60:63], v[120:123]
    ds_read2_b64 v[52:55], v5 offset0:16 offset1:17
    v_mfma_f32_16x16x32_bf16 v[124:127], a[56:59], v[60:63], v[124:127]
    v_mfma_f32_16x16x32_bf16 v[132:135], a[0:3], a[28:31], v[132:135]
    ds_read2_b64 v[56:59], v6 offset0:40 offset1:41
    v_mfma_f32_16x16x32_bf16 v[136:139], a[4:7], a[28:31], v[136:139]
    v_mfma_f32_16x16x32_bf16 v[140:143], a[8:11], a[28:31], v[140:143]
    v_mfma_f32_16x16x32_bf16 v[144:147], a[12:15], a[28:31], v[144:147]
    v_mfma_f32_16x16x32_bf16 v[148:151], a[16:19], a[28:31], v[148:151]
    v_mfma_f32_16x16x32_bf16 v[152:155], a[20:23], a[28:31], v[152:155]
    v_mfma_f32_16x16x32_bf16 v[156:159], a[24:27], a[28:31], v[156:159]
    s_waitcnt lgkmcnt(3)
    v_mfma_f32_16x16x32_bf16 v[132:135], a[32:35], a[60:63], v[132:135]
    ds_read2_b64 v[60:63], v6 offset0:32 offset1:33
    v_mfma_f32_16x16x32_bf16 v[136:139], a[36:39], a[60:63], v[136:139]
    v_mfma_f32_16x16x32_bf16 v[140:143], a[40:43], a[60:63], v[140:143]
    v_mfma_f32_16x16x32_bf16 v[144:147], a[44:47], a[60:63], v[144:147]
    v_mfma_f32_16x16x32_bf16 v[148:151], a[48:51], a[60:63], v[148:151]
    v_mfma_f32_16x16x32_bf16 v[152:155], a[52:55], a[60:63], v[152:155]
    v_mfma_f32_16x16x32_bf16 v[156:159], a[56:59], a[60:63], v[156:159]
    s_waitcnt lgkmcnt(3)
    v_mfma_f32_16x16x32_bf16 v[164:167], a[0:3], v[48:51], v[164:167]
    ds_read2_b64 a[28:31], v3 offset0:40 offset1:41
    v_mfma_f32_16x16x32_bf16 v[168:171], a[4:7], v[48:51], v[168:171]
    v_mfma_f32_16x16x32_bf16 v[172:175], a[8:11], v[48:51], v[172:175]
    v_mfma_f32_16x16x32_bf16 v[176:179], a[12:15], v[48:51], v[176:179]
    v_mfma_f32_16x16x32_bf16 v[180:183], a[16:19], v[48:51], v[180:183]
    v_mfma_f32_16x16x32_bf16 v[184:187], a[20:23], v[48:51], v[184:187]
    v_mfma_f32_16x16x32_bf16 v[188:191], a[24:27], v[48:51], v[188:191]
    s_waitcnt lgkmcnt(3)
    v_mfma_f32_16x16x32_bf16 v[164:167], a[32:35], v[52:55], v[164:167]
    ds_read2_b64 a[60:63], v3 offset0:32 offset1:33
    v_mfma_f32_16x16x32_bf16 v[168:171], a[36:39], v[52:55], v[168:171]
    v_mfma_f32_16x16x32_bf16 v[172:175], a[40:43], v[52:55], v[172:175]
    v_mfma_f32_16x16x32_bf16 v[176:179], a[44:47], v[52:55], v[176:179]
    v_mfma_f32_16x16x32_bf16 v[180:183], a[48:51], v[52:55], v[180:183]
    v_mfma_f32_16x16x32_bf16 v[184:187], a[52:55], v[52:55], v[184:187]
    v_mfma_f32_16x16x32_bf16 v[188:191], a[56:59], v[52:55], v[188:191]
    s_waitcnt lgkmcnt(3)
    v_mfma_f32_16x16x32_bf16 v[72:75], a[0:3], v[56:59], v[72:75]
    ds_read2_b64 v[48:51], v4 offset0:40 offset1:41
    v_mfma_f32_16x16x32_bf16 v[76:79], a[4:7], v[56:59], v[76:79]
    v_mfma_f32_16x16x32_bf16 v[80:83], a[8:11], v[56:59], v[80:83]
    v_add_f32 v69, v69, v100
    v_mfma_f32_16x16x32_bf16 v[84:87], a[12:15], v[56:59], v[84:87]
    v_add_f32 v70, v70, v101
    v_mfma_f32_16x16x32_bf16 v[88:91], a[16:19], v[56:59], v[88:91]
    v_add_f32 v71, v71, v102
    v_mfma_f32_16x16x32_bf16 v[92:95], a[20:23], v[56:59], v[92:95]
    v_add_f32 v32, v103, v134
    s_waitcnt lgkmcnt(3)
    v_mfma_f32_16x16x32_bf16 v[72:75], a[32:35], v[60:63], v[72:75]
    v_add_f32 v70, v70, v132
    v_mfma_f32_16x16x32_bf16 v[76:79], a[36:39], v[60:63], v[76:79]
    v_add_f32 v71, v71, v133
    v_mfma_f32_16x16x32_bf16 v[80:83], a[40:43], v[60:63], v[80:83]
    v_add_f32 v33, v135, v166
    v_mfma_f32_16x16x32_bf16 v[84:87], a[44:47], v[60:63], v[84:87]
    v_add_f32 v32, v32, v165
    v_mfma_f32_16x16x32_bf16 v[88:91], a[48:51], v[60:63], v[88:91]
    ds_bpermute_b32 v42, v8, v167
    v_mfma_f32_16x16x32_bf16 v[92:95], a[52:55], v[60:63], v[92:95]
    ds_bpermute_b32 v41, v8, v33
    s_waitcnt lgkmcnt(4)
    v_mfma_f32_16x16x32_bf16 v[104:107], a[0:3], a[28:31], v[104:107]
    ds_bpermute_b32 v40, v8, v32
    v_mfma_f32_16x16x32_bf16 v[108:111], a[4:7], a[28:31], v[108:111]
    v_add_f32 v71, v71, v164
    v_mfma_f32_16x16x32_bf16 v[112:115], a[8:11], a[28:31], v[112:115]
    s_waitcnt lgkmcnt(0)
    v_mfma_f32_16x16x32_bf16 v[116:119], a[12:15], a[28:31], v[116:119]
    v_cndmask_b32 v28, v40, v36, s[66:67]
    v_mfma_f32_16x16x32_bf16 v[120:123], a[16:19], a[28:31], v[120:123]
    v_cndmask_b32 v29, v41, v37, s[66:67]
    v_mfma_f32_16x16x32_bf16 v[124:127], a[20:23], a[28:31], v[124:127]
    v_cndmask_b32 v30, v42, v38, s[66:67]
    v_mfma_f32_16x16x32_bf16 v[104:107], a[32:35], a[60:63], v[104:107]
    ds_read2_b64 v[52:55], v4 offset0:32 offset1:33
    v_mfma_f32_16x16x32_bf16 v[108:111], a[36:39], a[60:63], v[108:111]
    v_add_f32 v68, v68, v28
    v_mfma_f32_16x16x32_bf16 v[112:115], a[40:43], a[60:63], v[112:115]
    v_add_f32 v69, v69, v29
    v_mfma_f32_16x16x32_bf16 v[116:119], a[44:47], a[60:63], v[116:119]
    v_add_f32 v70, v70, v30
    v_mfma_f32_16x16x32_bf16 v[120:123], a[48:51], a[60:63], v[120:123]
    v_cvt_pk_bf16_f32 v44, v68, v69
    v_mfma_f32_16x16x32_bf16 v[124:127], a[52:55], a[60:63], v[124:127]
    v_cvt_pk_bf16_f32 v46, v70, v71
    v_mfma_f32_16x16x32_bf16 v[136:139], a[0:3], v[48:51], v[136:139]
    ds_read2_b64 a[24:27], v5 offset0:40 offset1:41
    v_mfma_f32_16x16x32_bf16 v[140:143], a[4:7], v[48:51], v[140:143]
    global_store_dwordx4 v7, v[44:47], s[62:63] offset:1024 sc1
    v_mfma_f32_16x16x32_bf16 v[144:147], a[8:11], v[48:51], v[144:147]
    ds_read2_b64 a[56:59], v5 offset0:32 offset1:33
    v_mfma_f32_16x16x32_bf16 v[148:151], a[12:15], v[48:51], v[148:151]
    ds_read2_b64 v[56:59], v6 offset0:56 offset1:57
    v_mfma_f32_16x16x32_bf16 v[152:155], a[16:19], v[48:51], v[152:155]
    v_mfma_f32_16x16x32_bf16 v[156:159], a[20:23], v[48:51], v[156:159]
    s_waitcnt lgkmcnt(3)
    v_mfma_f32_16x16x32_bf16 v[136:139], a[32:35], v[52:55], v[136:139]
    ds_read2_b64 v[60:63], v6 offset0:48 offset1:49
    v_mfma_f32_16x16x32_bf16 v[140:143], a[36:39], v[52:55], v[140:143]
    v_mfma_f32_16x16x32_bf16 v[144:147], a[40:43], v[52:55], v[144:147]
    v_mfma_f32_16x16x32_bf16 v[148:151], a[44:47], v[52:55], v[148:151]
    v_mfma_f32_16x16x32_bf16 v[152:155], a[48:51], v[52:55], v[152:155]
    v_mfma_f32_16x16x32_bf16 v[156:159], a[52:55], v[52:55], v[156:159]
    s_waitcnt lgkmcnt(3)
    v_mfma_f32_16x16x32_bf16 v[168:171], a[0:3], a[24:27], v[168:171]
    ds_read2_b64 a[28:31], v3 offset0:56 offset1:57
    v_mfma_f32_16x16x32_bf16 v[172:175], a[4:7], a[24:27], v[172:175]
    v_mfma_f32_16x16x32_bf16 v[176:179], a[8:11], a[24:27], v[176:179]
    v_mfma_f32_16x16x32_bf16 v[180:183], a[12:15], a[24:27], v[180:183]
    v_mfma_f32_16x16x32_bf16 v[184:187], a[16:19], a[24:27], v[184:187]
    v_mfma_f32_16x16x32_bf16 v[188:191], a[20:23], a[24:27], v[188:191]
    s_waitcnt lgkmcnt(3)
    v_mfma_f32_16x16x32_bf16 v[168:171], a[32:35], a[56:59], v[168:171]
    ds_read2_b64 a[60:63], v3 offset0:48 offset1:49
    v_mfma_f32_16x16x32_bf16 v[172:175], a[36:39], a[56:59], v[172:175]
    v_mfma_f32_16x16x32_bf16 v[176:179], a[40:43], a[56:59], v[176:179]
    v_mfma_f32_16x16x32_bf16 v[180:183], a[44:47], a[56:59], v[180:183]
    v_mfma_f32_16x16x32_bf16 v[184:187], a[48:51], a[56:59], v[184:187]
    v_mfma_f32_16x16x32_bf16 v[188:191], a[52:55], a[56:59], v[188:191]
    s_waitcnt lgkmcnt(3)
    v_mfma_f32_16x16x32_bf16 v[76:79], a[0:3], v[56:59], v[76:79]
    ds_read2_b64 v[48:51], v4 offset0:56 offset1:57
    v_mfma_f32_16x16x32_bf16 v[80:83], a[4:7], v[56:59], v[80:83]
    v_mfma_f32_16x16x32_bf16 v[84:87], a[8:11], v[56:59], v[84:87]
    v_add_f32 v73, v73, v104
    v_mfma_f32_16x16x32_bf16 v[88:91], a[12:15], v[56:59], v[88:91]
    v_add_f32 v74, v74, v105
    v_mfma_f32_16x16x32_bf16 v[92:95], a[16:19], v[56:59], v[92:95]
    v_add_f32 v75, v75, v106
    s_waitcnt lgkmcnt(3)
    v_mfma_f32_16x16x32_bf16 v[76:79], a[32:35], v[60:63], v[76:79]
    v_add_f32 v32, v107, v138
    v_mfma_f32_16x16x32_bf16 v[80:83], a[36:39], v[60:63], v[80:83]
    v_add_f32 v74, v74, v136
    v_mfma_f32_16x16x32_bf16 v[84:87], a[40:43], v[60:63], v[84:87]
    v_add_f32 v75, v75, v137
    v_mfma_f32_16x16x32_bf16 v[88:91], a[44:47], v[60:63], v[88:91]
    v_add_f32 v33, v139, v170
    v_mfma_f32_16x16x32_bf16 v[92:95], a[48:51], v[60:63], v[92:95]
    v_add_f32 v32, v32, v169
    s_waitcnt lgkmcnt(2)
    v_mfma_f32_16x16x32_bf16 v[108:111], a[0:3], a[28:31], v[108:111]
    ds_bpermute_b32 v38, v8, v171
    v_mfma_f32_16x16x32_bf16 v[112:115], a[4:7], a[28:31], v[112:115]
    ds_bpermute_b32 v37, v8, v33
    v_mfma_f32_16x16x32_bf16 v[116:119], a[8:11], a[28:31], v[116:119]
    ds_bpermute_b32 v36, v8, v32
    v_mfma_f32_16x16x32_bf16 v[120:123], a[12:15], a[28:31], v[120:123]
    v_add_f32 v75, v75, v168
    v_mfma_f32_16x16x32_bf16 v[124:127], a[16:19], a[28:31], v[124:127]
    s_waitcnt lgkmcnt(0)
    v_mfma_f32_16x16x32_bf16 v[108:111], a[32:35], a[60:63], v[108:111]
    ds_read2_b64 v[52:55], v4 offset0:48 offset1:49
    v_mfma_f32_16x16x32_bf16 v[112:115], a[36:39], a[60:63], v[112:115]
    v_cndmask_b32 v28, v36, v40, s[66:67]
    v_mfma_f32_16x16x32_bf16 v[116:119], a[40:43], a[60:63], v[116:119]
    v_cndmask_b32 v29, v37, v41, s[66:67]
    v_mfma_f32_16x16x32_bf16 v[120:123], a[44:47], a[60:63], v[120:123]
    v_cndmask_b32 v30, v38, v42, s[66:67]
    v_mfma_f32_16x16x32_bf16 v[124:127], a[48:51], a[60:63], v[124:127]
    v_add_f32 v72, v72, v28
    v_mfma_f32_16x16x32_bf16 v[140:143], a[0:3], v[48:51], v[140:143]
    ds_read2_b64 a[24:27], v5 offset0:56 offset1:57
    v_mfma_f32_16x16x32_bf16 v[144:147], a[4:7], v[48:51], v[144:147]
    v_add_f32 v73, v73, v29
    v_mfma_f32_16x16x32_bf16 v[148:151], a[8:11], v[48:51], v[148:151]
    v_add_f32 v74, v74, v30
    v_mfma_f32_16x16x32_bf16 v[152:155], a[12:15], v[48:51], v[152:155]
    v_cvt_pk_bf16_f32 v44, v72, v73
    v_mfma_f32_16x16x32_bf16 v[156:159], a[16:19], v[48:51], v[156:159]
    v_cvt_pk_bf16_f32 v46, v74, v75
    s_waitcnt lgkmcnt(1)
    v_mfma_f32_16x16x32_bf16 v[140:143], a[32:35], v[52:55], v[140:143]
    ds_read2_b64 a[56:59], v5 offset0:48 offset1:49
    v_mfma_f32_16x16x32_bf16 v[144:147], a[36:39], v[52:55], v[144:147]
    global_store_dwordx4 v7, v[44:47], s[62:63] offset:2048 sc1
    v_mfma_f32_16x16x32_bf16 v[148:151], a[40:43], v[52:55], v[148:151]
    ds_read2_b64 a[20:23], v6 offset0:72 offset1:73
    v_mfma_f32_16x16x32_bf16 v[152:155], a[44:47], v[52:55], v[152:155]
    ds_read2_b64 a[52:55], v6 offset0:64 offset1:65
    v_mfma_f32_16x16x32_bf16 v[156:159], a[48:51], v[52:55], v[156:159]
    s_waitcnt lgkmcnt(3)
    v_mfma_f32_16x16x32_bf16 v[172:175], a[0:3], a[24:27], v[172:175]
    ds_read2_b64 v[56:59], v3 offset0:72 offset1:73
    v_mfma_f32_16x16x32_bf16 v[176:179], a[4:7], a[24:27], v[176:179]
    v_mfma_f32_16x16x32_bf16 v[180:183], a[8:11], a[24:27], v[180:183]
    v_mfma_f32_16x16x32_bf16 v[184:187], a[12:15], a[24:27], v[184:187]
    v_mfma_f32_16x16x32_bf16 v[188:191], a[16:19], a[24:27], v[188:191]
    s_waitcnt lgkmcnt(3)
    v_mfma_f32_16x16x32_bf16 v[172:175], a[32:35], a[56:59], v[172:175]
    ds_read2_b64 v[60:63], v3 offset0:64 offset1:65
    v_mfma_f32_16x16x32_bf16 v[176:179], a[36:39], a[56:59], v[176:179]
    v_mfma_f32_16x16x32_bf16 v[180:183], a[40:43], a[56:59], v[180:183]
    v_mfma_f32_16x16x32_bf16 v[184:187], a[44:47], a[56:59], v[184:187]
    v_mfma_f32_16x16x32_bf16 v[188:191], a[48:51], a[56:59], v[188:191]
    s_waitcnt lgkmcnt(3)
    v_mfma_f32_16x16x32_bf16 v[80:83], a[0:3], a[20:23], v[80:83]
    ds_read2_b64 a[28:31], v4 offset0:72 offset1:73
    v_mfma_f32_16x16x32_bf16 v[84:87], a[4:7], a[20:23], v[84:87]
    v_mfma_f32_16x16x32_bf16 v[88:91], a[8:11], a[20:23], v[88:91]
    v_add_f32 v77, v77, v108
    v_mfma_f32_16x16x32_bf16 v[92:95], a[12:15], a[20:23], v[92:95]
    v_add_f32 v78, v78, v109
    s_waitcnt lgkmcnt(3)
    v_mfma_f32_16x16x32_bf16 v[80:83], a[32:35], a[52:55], v[80:83]
    v_add_f32 v79, v79, v110
    v_mfma_f32_16x16x32_bf16 v[84:87], a[36:39], a[52:55], v[84:87]
    v_add_f32 v32, v111, v142
    v_mfma_f32_16x16x32_bf16 v[88:91], a[40:43], a[52:55], v[88:91]
    v_add_f32 v78, v78, v140
    v_mfma_f32_16x16x32_bf16 v[92:95], a[44:47], a[52:55], v[92:95]
    v_add_f32 v79, v79, v141
    s_waitcnt lgkmcnt(2)
    v_mfma_f32_16x16x32_bf16 v[112:115], a[0:3], v[56:59], v[112:115]
    v_add_f32 v33, v143, v174
    v_mfma_f32_16x16x32_bf16 v[116:119], a[4:7], v[56:59], v[116:119]
    v_add_f32 v32, v32, v173
    v_mfma_f32_16x16x32_bf16 v[120:123], a[8:11], v[56:59], v[120:123]
    ds_bpermute_b32 v42, v8, v175
    v_mfma_f32_16x16x32_bf16 v[124:127], a[12:15], v[56:59], v[124:127]
    ds_bpermute_b32 v41, v8, v33
    s_waitcnt lgkmcnt(3)
    v_mfma_f32_16x16x32_bf16 v[112:115], a[32:35], v[60:63], v[112:115]
    ds_read2_b64 a[60:63], v4 offset0:64 offset1:65
    v_mfma_f32_16x16x32_bf16 v[116:119], a[36:39], v[60:63], v[116:119]
    ds_bpermute_b32 v40, v8, v32
    v_mfma_f32_16x16x32_bf16 v[120:123], a[40:43], v[60:63], v[120:123]
    v_add_f32 v79, v79, v172
    v_mfma_f32_16x16x32_bf16 v[124:127], a[44:47], v[60:63], v[124:127]
    s_waitcnt lgkmcnt(0)
    v_mfma_f32_16x16x32_bf16 v[144:147], a[0:3], a[28:31], v[144:147]
    ds_read2_b64 v[48:51], v5 offset0:72 offset1:73
    v_mfma_f32_16x16x32_bf16 v[148:151], a[4:7], a[28:31], v[148:151]
    v_cndmask_b32 v28, v40, v36, s[66:67]
    v_mfma_f32_16x16x32_bf16 v[152:155], a[8:11], a[28:31], v[152:155]
    v_cndmask_b32 v29, v41, v37, s[66:67]
    v_mfma_f32_16x16x32_bf16 v[156:159], a[12:15], a[28:31], v[156:159]
    v_cndmask_b32 v30, v42, v38, s[66:67]
    v_mfma_f32_16x16x32_bf16 v[144:147], a[32:35], a[60:63], v[144:147]
    ds_read2_b64 v[52:55], v5 offset0:64 offset1:65
    v_mfma_f32_16x16x32_bf16 v[148:151], a[36:39], a[60:63], v[148:151]
    v_add_f32 v76, v76, v28
    v_mfma_f32_16x16x32_bf16 v[152:155], a[40:43], a[60:63], v[152:155]
    v_add_f32 v77, v77, v29
    v_mfma_f32_16x16x32_bf16 v[156:159], a[44:47], a[60:63], v[156:159]
    v_add_f32 v78, v78, v30
    s_waitcnt lgkmcnt(1)
    v_mfma_f32_16x16x32_bf16 v[176:179], a[0:3], v[48:51], v[176:179]
    ds_read2_b64 a[24:27], v6 offset0:88 offset1:89
    v_mfma_f32_16x16x32_bf16 v[180:183], a[4:7], v[48:51], v[180:183]
    v_cvt_pk_bf16_f32 v44, v76, v77
    v_mfma_f32_16x16x32_bf16 v[184:187], a[8:11], v[48:51], v[184:187]
    v_cvt_pk_bf16_f32 v46, v78, v79
    v_mfma_f32_16x16x32_bf16 v[188:191], a[12:15], v[48:51], v[188:191]
    global_store_dwordx4 v7, v[44:47], s[62:63] offset:3072 sc1
    s_waitcnt lgkmcnt(1)
    v_mfma_f32_16x16x32_bf16 v[176:179], a[32:35], v[52:55], v[176:179]
    ds_read2_b64 a[56:59], v6 offset0:80 offset1:81
    v_mfma_f32_16x16x32_bf16 v[180:183], a[36:39], v[52:55], v[180:183]
    ds_read2_b64 a[16:19], v3 offset0:88 offset1:89
    v_mfma_f32_16x16x32_bf16 v[184:187], a[40:43], v[52:55], v[184:187]
    ds_read2_b64 a[48:51], v3 offset0:80 offset1:81
    v_mfma_f32_16x16x32_bf16 v[188:191], a[44:47], v[52:55], v[188:191]
    s_waitcnt lgkmcnt(3)
    v_mfma_f32_16x16x32_bf16 v[84:87], a[0:3], a[24:27], v[84:87]
    ds_read2_b64 a[20:23], v4 offset0:88 offset1:89
    v_mfma_f32_16x16x32_bf16 v[88:91], a[4:7], a[24:27], v[88:91]
    v_mfma_f32_16x16x32_bf16 v[92:95], a[8:11], a[24:27], v[92:95]
    v_add_f32 v81, v81, v112
    v_add_f32 v82, v82, v113
    s_waitcnt lgkmcnt(3)
    v_mfma_f32_16x16x32_bf16 v[84:87], a[32:35], a[56:59], v[84:87]
    v_add_f32 v83, v83, v114
    v_add_f32 v32, v115, v146
    v_mfma_f32_16x16x32_bf16 v[88:91], a[36:39], a[56:59], v[88:91]
    v_add_f32 v82, v82, v144
    v_add_f32 v83, v83, v145
    v_mfma_f32_16x16x32_bf16 v[92:95], a[40:43], a[56:59], v[92:95]
    v_add_f32 v33, v147, v178
    v_add_f32 v32, v32, v177
    s_waitcnt lgkmcnt(2)
    v_mfma_f32_16x16x32_bf16 v[116:119], a[0:3], a[16:19], v[116:119]
    ds_bpermute_b32 v38, v8, v179
    ds_bpermute_b32 v37, v8, v33
    v_mfma_f32_16x16x32_bf16 v[120:123], a[4:7], a[16:19], v[120:123]
    ds_bpermute_b32 v36, v8, v32
    v_add_f32 v83, v83, v176
    v_mfma_f32_16x16x32_bf16 v[124:127], a[8:11], a[16:19], v[124:127]
    s_waitcnt lgkmcnt(0)
    v_mfma_f32_16x16x32_bf16 v[116:119], a[32:35], a[48:51], v[116:119]
    ds_read2_b64 a[52:55], v4 offset0:80 offset1:81
    v_mfma_f32_16x16x32_bf16 v[120:123], a[36:39], a[48:51], v[120:123]
    v_cndmask_b32 v28, v36, v40, s[66:67]
    v_mfma_f32_16x16x32_bf16 v[124:127], a[40:43], a[48:51], v[124:127]
    v_cndmask_b32 v29, v37, v41, s[66:67]
    v_mfma_f32_16x16x32_bf16 v[148:151], a[0:3], a[20:23], v[148:151]
    ds_read2_b64 v[56:59], v5 offset0:88 offset1:89
    v_mfma_f32_16x16x32_bf16 v[152:155], a[4:7], a[20:23], v[152:155]
    v_cndmask_b32 v30, v38, v42, s[66:67]
    v_mfma_f32_16x16x32_bf16 v[156:159], a[8:11], a[20:23], v[156:159]
    v_add_f32 v80, v80, v28
    s_waitcnt lgkmcnt(1)
    v_mfma_f32_16x16x32_bf16 v[148:151], a[32:35], a[52:55], v[148:151]
    ds_read2_b64 v[60:63], v5 offset0:80 offset1:81
    v_mfma_f32_16x16x32_bf16 v[152:155], a[36:39], a[52:55], v[152:155]
    v_add_f32 v81, v81, v29
    v_mfma_f32_16x16x32_bf16 v[156:159], a[40:43], a[52:55], v[156:159]
    v_add_f32 v82, v82, v30
    s_waitcnt lgkmcnt(1)
    v_mfma_f32_16x16x32_bf16 v[180:183], a[0:3], v[56:59], v[180:183]
    ds_read2_b64 a[28:31], v6 offset0:104 offset1:105
    v_mfma_f32_16x16x32_bf16 v[184:187], a[4:7], v[56:59], v[184:187]
    v_cvt_pk_bf16_f32 v44, v80, v81
    v_mfma_f32_16x16x32_bf16 v[188:191], a[8:11], v[56:59], v[188:191]
    v_cvt_pk_bf16_f32 v46, v82, v83
    s_waitcnt lgkmcnt(1)
    v_mfma_f32_16x16x32_bf16 v[180:183], a[32:35], v[60:63], v[180:183]
    ds_read2_b64 a[60:63], v6 offset0:96 offset1:97
    v_mfma_f32_16x16x32_bf16 v[184:187], a[36:39], v[60:63], v[184:187]
    global_store_dwordx4 v11, v[44:47], s[62:63] offset:0 sc1
    v_mfma_f32_16x16x32_bf16 v[188:191], a[40:43], v[60:63], v[188:191]
    ds_read2_b64 v[48:51], v3 offset0:104 offset1:105
    s_waitcnt lgkmcnt(2)
    v_mfma_f32_16x16x32_bf16 v[88:91], a[0:3], a[28:31], v[88:91]
    ds_read2_b64 v[52:55], v3 offset0:96 offset1:97
    v_mfma_f32_16x16x32_bf16 v[92:95], a[4:7], a[28:31], v[92:95]
    ds_read2_b64 a[12:15], v4 offset0:104 offset1:105
    s_waitcnt lgkmcnt(3)
    v_mfma_f32_16x16x32_bf16 v[88:91], a[32:35], a[60:63], v[88:91]
    v_add_f32 v85, v85, v116
    v_add_f32 v86, v86, v117
    v_add_f32 v87, v87, v118
    v_mfma_f32_16x16x32_bf16 v[92:95], a[36:39], a[60:63], v[92:95]
    v_add_f32 v32, v119, v150
    v_add_f32 v86, v86, v148
    s_waitcnt lgkmcnt(2)
    v_mfma_f32_16x16x32_bf16 v[120:123], a[0:3], v[48:51], v[120:123]
    v_add_f32 v87, v87, v149
    v_add_f32 v33, v151, v182
    v_mfma_f32_16x16x32_bf16 v[124:127], a[4:7], v[48:51], v[124:127]
    v_add_f32 v32, v32, v181
    ds_bpermute_b32 v42, v8, v183
    s_waitcnt lgkmcnt(2)
    v_mfma_f32_16x16x32_bf16 v[120:123], a[32:35], v[52:55], v[120:123]
    ds_read2_b64 a[44:47], v4 offset0:96 offset1:97
    ds_bpermute_b32 v41, v8, v33
    v_mfma_f32_16x16x32_bf16 v[124:127], a[36:39], v[52:55], v[124:127]
    ds_bpermute_b32 v40, v8, v32
    v_add_f32 v87, v87, v180
    s_waitcnt lgkmcnt(4)
    v_mfma_f32_16x16x32_bf16 v[152:155], a[0:3], a[12:15], v[152:155]
    ds_read2_b64 a[24:27], v5 offset0:104 offset1:105
    s_waitcnt lgkmcnt(1)
    v_mfma_f32_16x16x32_bf16 v[156:159], a[4:7], a[12:15], v[156:159]
    v_cndmask_b32 v28, v40, v36, s[66:67]
    v_cndmask_b32 v29, v41, v37, s[66:67]
    v_mfma_f32_16x16x32_bf16 v[152:155], a[32:35], a[44:47], v[152:155]
    ds_read2_b64 a[56:59], v5 offset0:96 offset1:97
    v_cndmask_b32 v30, v42, v38, s[66:67]
    v_mfma_f32_16x16x32_bf16 v[156:159], a[36:39], a[44:47], v[156:159]
    v_add_f32 v84, v84, v28
    v_add_f32 v85, v85, v29
    s_waitcnt lgkmcnt(1)
    v_mfma_f32_16x16x32_bf16 v[184:187], a[0:3], a[24:27], v[184:187]
    ds_read2_b64 a[16:19], v6 offset0:120 offset1:121
    v_add_f32 v86, v86, v30
    v_mfma_f32_16x16x32_bf16 v[188:191], a[4:7], a[24:27], v[188:191]
    v_cvt_pk_bf16_f32 v44, v84, v85
    v_cvt_pk_bf16_f32 v46, v86, v87
    s_waitcnt lgkmcnt(1)
    v_mfma_f32_16x16x32_bf16 v[184:187], a[32:35], a[56:59], v[184:187]
    ds_read2_b64 a[48:51], v6 offset0:112 offset1:113
    v_mfma_f32_16x16x32_bf16 v[188:191], a[36:39], a[56:59], v[188:191]
    global_store_dwordx4 v11, v[44:47], s[62:63] offset:1024 sc1
    s_waitcnt lgkmcnt(1)
    v_mfma_f32_16x16x32_bf16 v[92:95], a[0:3], a[16:19], v[92:95]
    ds_read2_b64 a[20:23], v3 offset0:120 offset1:121
    s_waitcnt lgkmcnt(1)
    v_mfma_f32_16x16x32_bf16 v[92:95], a[32:35], a[48:51], v[92:95]
    ds_read2_b64 a[52:55], v3 offset0:112 offset1:113
    s_waitcnt lgkmcnt(1)
    v_mfma_f32_16x16x32_bf16 v[124:127], a[0:3], a[20:23], v[124:127]
    ds_read2_b64 v[56:59], v4 offset0:120 offset1:121
    v_add_f32 v89, v89, v120
    v_add_f32 v90, v90, v121
    v_add_f32 v91, v91, v122
    v_add_f32 v32, v123, v154
    s_waitcnt lgkmcnt(1)
    v_mfma_f32_16x16x32_bf16 v[124:127], a[32:35], a[52:55], v[124:127]
    ds_read2_b64 v[60:63], v4 offset0:112 offset1:113
    v_add_f32 v90, v90, v152
    v_add_f32 v91, v91, v153
    v_add_f32 v33, v155, v186
    v_add_f32 v32, v32, v185
    s_waitcnt lgkmcnt(1)
    v_mfma_f32_16x16x32_bf16 v[156:159], a[0:3], v[56:59], v[156:159]
    ds_read2_b64 a[8:11], v5 offset0:120 offset1:121
    ds_bpermute_b32 v38, v8, v187
    ds_bpermute_b32 v37, v8, v33
    ds_bpermute_b32 v36, v8, v32
    v_add_f32 v91, v91, v184
    s_waitcnt lgkmcnt(4)
    v_mfma_f32_16x16x32_bf16 v[156:159], a[32:35], v[60:63], v[156:159]
    ds_read2_b64 a[40:43], v5 offset0:112 offset1:113
    s_waitcnt lgkmcnt(1)
    v_cndmask_b32 v28, v36, v40, s[66:67]
    v_cndmask_b32 v29, v37, v41, s[66:67]
    v_cndmask_b32 v30, v38, v42, s[66:67]
    v_mfma_f32_16x16x32_bf16 v[188:191], a[0:3], a[8:11], v[188:191]
    v_add_f32 v88, v88, v28
    v_add_f32 v89, v89, v29
    v_add_f32 v90, v90, v30
    v_cvt_pk_bf16_f32 v44, v88, v89
    s_waitcnt lgkmcnt(0)
    v_mfma_f32_16x16x32_bf16 v[188:191], a[32:35], a[40:43], v[188:191]
    v_cvt_pk_bf16_f32 v46, v90, v91
    global_store_dwordx4 v11, v[44:47], s[62:63] offset:2048 sc1
    s_nop 7
    s_nop 1
    v_add_f32 v93, v93, v124
    v_add_f32 v94, v94, v125
    v_add_f32 v95, v95, v126
    v_add_f32 v32, v127, v158
    v_add_f32 v94, v94, v156
    v_add_f32 v95, v95, v157
    v_add_f32 v33, v159, v190
    v_add_f32 v32, v32, v189
    ds_bpermute_b32 v42, v8, v191
    ds_bpermute_b32 v41, v8, v33
    ds_bpermute_b32 v40, v8, v32
    v_add_f32 v95, v95, v188
    s_waitcnt lgkmcnt(0)
    v_cndmask_b32 v28, v40, v36, s[66:67]
    v_cndmask_b32 v29, v41, v37, s[66:67]
    v_cndmask_b32 v30, v42, v38, s[66:67]
    v_add_f32 v92, v92, v28
    v_add_f32 v93, v93, v29
    v_add_f32 v94, v94, v30
    v_cvt_pk_bf16_f32 v44, v92, v93
    v_cvt_pk_bf16_f32 v46, v94, v95
    global_store_dwordx4 v11, v[44:47], s[62:63] offset:3072 sc1
    s_mov_b64 exec, 1
    ds_add_u32 v9, v10
    s_mov_b64 exec, -1
    s_branch L_epi
L_helper:
    s_mov_b32 s40, s4
    s_and_b32 s41, s5, 0xffff
    s_mov_b32 s42, 2359296
    s_mov_b32 s43, 0x00020000
    s_mul_i32 s58, s72, 36864
    s_mul_i32 s60, s72, 4160
    s_add_u32 s60, s60, 87504
    s_mov_b32 m0, s60
    s_nop 0
    buffer_load_dwordx4 v3, s[40:43], s58 offen  lds
    s_add_u32 s58, s58, 9216
    s_add_u32 s60, s60, 1040
    s_mov_b32 m0, s60
    s_nop 0
    buffer_load_dwordx4 v3, s[40:43], s58 offen  lds
    s_add_u32 s58, s58, 9216
    s_add_u32 s60, s60, 1040
    s_mov_b32 m0, s60
    s_nop 0
    buffer_load_dwordx4 v3, s[40:43], s58 offen  lds
    s_add_u32 s58, s58, 9216
    s_add_u32 s60, s60, 1040
    s_mov_b32 m0, s60
    s_nop 0
    buffer_load_dwordx4 v3, s[40:43], s58 offen  lds
    s_add_u32 s58, s58, 9216
    s_add_u32 s60, s60, 1040
    s_cmp_eq_u32 s3, 4
    s_cbranch_scc1 L_h4_15
    s_cmp_eq_u32 s3, 5
    s_cbranch_scc1 L_h5_16
    s_branch L_he_17
L_h4_15:
    s_lshl_b32 s55, s77, 10
    v_lshlrev_b32 v10, 4, v0
    v_add_u32 v11, s55, v10
    s_add_u32 s56, s30, 4734976
    s_addc_u32 s57, s31, 0
    s_mov_b32 s54, 0
L_pl_18:
    global_load_dwordx4 v[12:15], v11, s[56:57] sc1
    s_waitcnt vmcnt(0)
    v_xor_b32 v16, s48, v13
    v_xor_b32 v17, s48, v15
    v_or_b32 v16, v16, v17
    v_cmp_ne_u32 vcc, 0, v16
    s_add_u32 s54, s54, 1
    s_nop 3
    s_cmp_eq_u64 vcc, 0
    s_cbranch_scc1 L_pld_19
    s_sleep 4
    s_cmp_lt_u32 s54, 400000
    s_cbranch_scc1 L_pl_18
L_pld_19:
    v_lshlrev_b32 v20, 16, v12
    v_and_b32 v21, s50, v12
    v_lshlrev_b32 v22, 16, v14
    v_and_b32 v23, s50, v14
    v_rcp_f32 v21, v21
    v_rcp_f32 v23, v23
    v_add_u32 v10, 51520, v10
    s_nop 0
    ds_write_b128 v10, v[20:23]
    s_branch L_he_17
L_h5_16:
    v_and_b32 v10, 7, v0
    v_lshlrev_b32 v11, 3, v10
    s_add_u32 s56, s30, 4757504
    s_addc_u32 s57, s31, 0
    s_mov_b32 s54, 0
L_pl_20:
    global_load_dwordx2 v[12:13], v11, s[56:57] sc1
    s_waitcnt vmcnt(0)
    v_xor_b32 v16, s48, v13
    v_cmp_ne_u32 vcc, 0, v16
    s_add_u32 s54, s54, 1
    s_nop 3
    s_cmp_eq_u64 vcc, 0
    s_cbranch_scc1 L_pld_21
    s_sleep 4
    s_cmp_lt_u32 s54, 400000
    s_cbranch_scc1 L_pl_20
L_pld_21:
    v_and_b32 v12, 0x7ff, v12
    v_xor_b32 v12, 0x7ff, v12
    s_lshl_b32 s55, s77, 7
    v_subrev_u32 v12, s55, v12
    v_cmp_gt_u32 vcc, 128, v12
    v_or_b32 v13, 0x80, v10
    v_add_u32 v12, 51392, v12
    s_and_b32 vcc_lo, vcc_lo, 0xff
    s_mov_b32 vcc_hi, 0
    s_mov_b64 exec, vcc
    s_cbranch_execz L_nsel_22
    ds_write_b8 v12, v13
L_nsel_22:
    s_mov_b64 exec, -1
L_he_17:
    s_waitcnt vmcnt(0) lgkmcnt(0)
    v_mov_b32 v10, 51328
    v_mov_b32 v11, 1
    s_mov_b64 exec, 1
    ds_add_u32 v10, v11 offset:4
    s_mov_b64 exec, -1
    v_mov_b32 v10, 51328
    s_mov_b32 s55, 0
L_ls_23:
    ds_read_b32 v11, v10 offset:0
    s_waitcnt lgkmcnt(0)
    v_readfirstlane_b32 s54, v11
    s_add_u32 s55, s55, 1
    s_cmp_ge_u32 s55, 1600000
    s_cbranch_scc1 L_ls_23_d
    s_cmp_ge_u32 s54, 4
    s_cbranch_scc1 L_ls_23_d
    s_sleep 2
    s_branch L_ls_23
L_ls_23_d:
L_epi:
    v_mov_b32 v10, 51328
    s_mov_b32 s55, 0
L_ls_24:
    ds_read_b32 v11, v10 offset:4
    s_waitcnt lgkmcnt(0)
    v_readfirstlane_b32 s54, v11
    s_add_u32 s55, s55, 1
    s_cmp_ge_u32 s55, 1600000
    s_cbranch_scc1 L_ls_24_d
    s_cmp_ge_u32 s54, 4
    s_cbranch_scc1 L_ls_24_d
    s_sleep 1
    s_branch L_ls_24
L_ls_24_d:
    v_and_b32 v2, 7, v0
    v_lshrrev_b32 v1, 3, v0
    s_and_b32 s55, s3, 1
    s_lshl_b32 s55, s55, 3
    v_add_u32 v6, s55, v2
    s_lshr_b32 s56, s3, 1
    s_lshl_b32 s56, s56, 3
    v_add_u32 v7, s56, v1
    s_lshl_b32 s55, s76, 19
    s_lshl_b32 s56, s77, 9
    s_add_u32 s55, s55, s56
    v_lshlrev_b32 v8, 14, v7
    v_lshl_add_u32 v8, v6, 5, v8
    v_add_u32 v8, s55, v8
    v_add_u32 v9, 8192, v8
    s_add_u32 s62, s30, 16777216
    s_addc_u32 s63, s31, 0
    v_mul_u32_u24 v10, 1040, v6
    v_lshl_add_u32 v10, v7, 2, v10
    v_add_u32 v11, 87504, v10
    ds_read_b32 v16, v11 offset:0
    ds_read_b32 v17, v11 offset:128
    ds_read_b32 v18, v11 offset:256
    ds_read_b32 v19, v11 offset:384
    ds_read_b32 v20, v11 offset:512
    ds_read_b32 v21, v11 offset:640
    ds_read_b32 v22, v11 offset:768
    ds_read_b32 v23, v11 offset:896
    s_lshl_b32 s55, s3, 11
    v_lshlrev_b32 v12, 5, v0
    v_add_u32 v12, s55, v12
    v_add_u32 v12, 34944, v12
    ds_read_b128 v[24:27], v12
    ds_read_b128 v[28:31], v12 offset:16
    v_lshlrev_b32 v12, 6, v6
    v_add_u32 v12, 51520, v12
    ds_read_b128 v[32:35], v12 offset:0
    ds_read_b128 v[36:39], v12 offset:16
    ds_read_b128 v[40:43], v12 offset:32
    ds_read_b128 v[44:47], v12 offset:48
    v_lshlrev_b32 v12, 3, v6
    v_add_u32 v12, 51392, v12
    ds_read_b64 v[48:49], v12
    v_lshlrev_b32 v13, 2, v7
    v_add_u32 v13, 53056, v13
    ds_read_b32 v50, v13
    s_waitcnt lgkmcnt(0)
    v_lshlrev_b32 v52, 16, v50
    v_and_b32 v53, s50, v50
    v_lshlrev_b32 v96, 16, v16
    v_and_b32 v97, s50, v16
    v_sub_f32 v80, v96, v32
    v_sub_f32 v81, v97, v32
    v_mul_f32 v80, v80, v33
    v_mul_f32 v81, v81, v33
    v_lshlrev_b32 v54, 16, v24
    v_fma_f32 v54, v54, v52, 1.0
    v_fma_f32 v96, v80, v54, v96
    v_lshlrev_b32 v55, 16, v28
    v_fma_f32 v55, v55, v53, 1.0
    v_fma_f32 v97, v81, v55, v97
    v_lshlrev_b32 v98, 16, v17
    v_and_b32 v99, s50, v17
    v_sub_f32 v82, v98, v34
    v_sub_f32 v83, v99, v34
    v_mul_f32 v82, v82, v35
    v_mul_f32 v83, v83, v35
    v_and_b32 v54, s50, v24
    v_fma_f32 v54, v54, v52, 1.0
    v_fma_f32 v98, v82, v54, v98
    v_and_b32 v55, s50, v28
    v_fma_f32 v55, v55, v53, 1.0
    v_fma_f32 v99, v83, v55, v99
    v_lshlrev_b32 v100, 16, v18
    v_and_b32 v101, s50, v18
    v_sub_f32 v84, v100, v36
    v_sub_f32 v85, v101, v36
    v_mul_f32 v84, v84, v37
    v_mul_f32 v85, v85, v37
    v_lshlrev_b32 v54, 16, v25
    v_fma_f32 v54, v54, v52, 1.0
    v_fma_f32 v100, v84, v54, v100
    v_lshlrev_b32 v55, 16, v29
    v_fma_f32 v55, v55, v53, 1.0
    v_fma_f32 v101, v85, v55, v101
    v_lshlrev_b32 v102, 16, v19
    v_and_b32 v103, s50, v19
    v_sub_f32 v86, v102, v38
    v_sub_f32 v87, v103, v38
    v_mul_f32 v86, v86, v39
    v_mul_f32 v87, v87, v39
    v_and_b32 v54, s50, v25
    v_fma_f32 v54, v54, v52, 1.0
    v_fma_f32 v102, v86, v54, v102
    v_and_b32 v55, s50, v29
    v_fma_f32 v55, v55, v53, 1.0
    v_fma_f32 v103, v87, v55, v103
    v_lshlrev_b32 v104, 16, v20
    v_and_b32 v105, s50, v20
    v_sub_f32 v88, v104, v40
    v_sub_f32 v89, v105, v40
    v_mul_f32 v88, v88, v41
    v_mul_f32 v89, v89, v41
    v_lshlrev_b32 v54, 16, v26
    v_fma_f32 v54, v54, v52, 1.0
    v_fma_f32 v104, v88, v54, v104
    v_lshlrev_b32 v55, 16, v30
    v_fma_f32 v55, v55, v53, 1.0
    v_fma_f32 v105, v89, v55, v105
    v_lshlrev_b32 v106, 16, v21
    v_and_b32 v107, s50, v21
    v_sub_f32 v90, v106, v42
    v_sub_f32 v91, v107, v42
    v_mul_f32 v90, v90, v43
    v_mul_f32 v91, v91, v43
    v_and_b32 v54, s50, v26
    v_fma_f32 v54, v54, v52, 1.0
    v_fma_f32 v106, v90, v54, v106
    v_and_b32 v55, s50, v30
    v_fma_f32 v55, v55, v53, 1.0
    v_fma_f32 v107, v91, v55, v107
    v_lshlrev_b32 v108, 16, v22
    v_and_b32 v109, s50, v22
    v_sub_f32 v92, v108, v44
    v_sub_f32 v93, v109, v44
    v_mul_f32 v92, v92, v45
    v_mul_f32 v93, v93, v45
    v_lshlrev_b32 v54, 16, v27
    v_fma_f32 v54, v54, v52, 1.0
    v_fma_f32 v108, v92, v54, v108
    v_lshlrev_b32 v55, 16, v31
    v_fma_f32 v55, v55, v53, 1.0
    v_fma_f32 v109, v93, v55, v109
    v_lshlrev_b32 v110, 16, v23
    v_and_b32 v111, s50, v23
    v_sub_f32 v94, v110, v46
    v_sub_f32 v95, v111, v46
    v_mul_f32 v94, v94, v47
    v_mul_f32 v95, v95, v47
    v_and_b32 v54, s50, v27
    v_fma_f32 v54, v54, v52, 1.0
    v_fma_f32 v110, v94, v54, v110
    v_and_b32 v55, s50, v31
    v_fma_f32 v55, v55, v53, 1.0
    v_fma_f32 v111, v95, v55, v111
    v_add_u32 v11, 53184, v10
    s_lshl_b32 s55, s3, 3
    v_add_u32 v120, s55, v1
    v_lshrrev_b32 v121, 3, v120
    v_mul_u32_u24 v121, 1040, v121
    v_and_b32 v122, 7, v120
    v_lshl_add_u32 v121, v122, 7, v121
    v_lshl_add_u32 v121, v2, 4, v121
    v_add_u32 v121, 53184, v121
    v_add_u32 v122, 51392, v120
    ds_read_u8 v124, v122
    ds_read_u8 v125, v122 offset:64
    s_mov_b32 s44, s26
    s_and_b32 s45, s27, 0xffff
    s_mov_b32 s46, 2359296
    s_mov_b32 s47, 0x00020000
    s_mul_i32 s55, s77, 147456
    s_lshl_b32 s56, s76, 7
    s_add_u32 s55, s55, s56
    v_mul_u32_u24 v122, 1152, v120
    v_lshl_add_u32 v122, v2, 4, v122
    v_add_u32 v122, s55, v122
    v_add_u32 v123, 73728, v122
    s_waitcnt lgkmcnt(0)
    v_lshlrev_b32 v124, 24, v124
    v_and_b32 v124, 0x80000000, v124
    v_or_b32 v122, v122, v124
    v_lshlrev_b32 v125, 24, v125
    v_and_b32 v125, 0x80000000, v125
    v_or_b32 v123, v123, v125
    s_mov_b32 s54, 0
L_pl_25:
    global_load_dwordx4 v[64:67], v8, s[62:63] sc1
    global_load_dwordx4 v[68:71], v8, s[62:63] offset:16 sc1
    global_load_dwordx4 v[72:75], v9, s[62:63] sc1
    global_load_dwordx4 v[76:79], v9, s[62:63] offset:16 sc1
    s_waitcnt vmcnt(0)
    v_xor_b32 v14, s48, v65
    v_xor_b32 v52, s48, v67
    v_xor_b32 v53, s48, v69
    v_or3_b32 v14, v14, v52, v53
    v_xor_b32 v52, s48, v71
    v_xor_b32 v53, s48, v73
    v_or3_b32 v14, v14, v52, v53
    v_xor_b32 v52, s48, v75
    v_xor_b32 v53, s48, v77
    v_or3_b32 v14, v14, v52, v53
    v_xor_b32 v52, s48, v79
    v_or_b32 v14, v14, v52
    v_cmp_ne_u32 vcc, 0, v14
    s_add_u32 s54, s54, 1
    s_nop 3
    s_cmp_eq_u64 vcc, 0
    s_cbranch_scc1 L_pld_26
    s_sleep 1
    s_cmp_lt_u32 s54, 400000
    s_cbranch_scc1 L_pl_25
L_pld_26:
    v_lshlrev_b32 v54, 16, v64
    v_fma_f32 v96, v80, v54, v96
    v_lshlrev_b32 v55, 16, v72
    v_fma_f32 v97, v81, v55, v97
    v_cvt_pk_bf16_f32 v112, v96, v97
    ds_write_b32 v11, v112 offset:0
    v_and_b32 v54, s50, v64
    v_fma_f32 v98, v82, v54, v98
    v_and_b32 v55, s50, v72
    v_fma_f32 v99, v83, v55, v99
    v_cvt_pk_bf16_f32 v113, v98, v99
    ds_write_b32 v11, v113 offset:128
    v_lshlrev_b32 v54, 16, v66
    v_fma_f32 v100, v84, v54, v100
    v_lshlrev_b32 v55, 16, v74
    v_fma_f32 v101, v85, v55, v101
    v_cvt_pk_bf16_f32 v114, v100, v101
    ds_write_b32 v11, v114 offset:256
    v_and_b32 v54, s50, v66
    v_fma_f32 v102, v86, v54, v102
    v_and_b32 v55, s50, v74
    v_fma_f32 v103, v87, v55, v103
    v_cvt_pk_bf16_f32 v115, v102, v103
    ds_write_b32 v11, v115 offset:384
    v_lshlrev_b32 v54, 16, v68
    v_fma_f32 v104, v88, v54, v104
    v_lshlrev_b32 v55, 16, v76
    v_fma_f32 v105, v89, v55, v105
    v_cvt_pk_bf16_f32 v116, v104, v105
    ds_write_b32 v11, v116 offset:512
    v_and_b32 v54, s50, v68
    v_fma_f32 v106, v90, v54, v106
    v_and_b32 v55, s50, v76
    v_fma_f32 v107, v91, v55, v107
    v_cvt_pk_bf16_f32 v117, v106, v107
    ds_write_b32 v11, v117 offset:640
    v_lshlrev_b32 v54, 16, v70
    v_fma_f32 v108, v92, v54, v108
    v_lshlrev_b32 v55, 16, v78
    v_fma_f32 v109, v93, v55, v109
    v_cvt_pk_bf16_f32 v118, v108, v109
    ds_write_b32 v11, v118 offset:768
    v_and_b32 v54, s50, v70
    v_fma_f32 v110, v94, v54, v110
    v_and_b32 v55, s50, v78
    v_fma_f32 v111, v95, v55, v111
    v_cvt_pk_bf16_f32 v119, v110, v111
    ds_write_b32 v11, v119 offset:896
    v_or_b32 v12, v48, v49
    v_cmp_ne_u32 vcc, 0, v12
    s_nop 3
    s_cmp_eq_u64 vcc, 0
    s_cbranch_scc1 L_nt1_27
    s_add_u32 s64, s30, 4759552
    s_addc_u32 s65, s31, 0
    s_lshl_b32 s55, s76, 6
    v_lshlrev_b32 v13, 1, v7
    v_add_u32 v13, s55, v13
    v_bfe_u32 v12, v48, 0, 8
    v_cmp_lt_u32 vcc, 0x7f, v12
    s_and_saveexec_b64 s[66:67], vcc
    s_cbranch_execz L_t1i_28
    v_and_b32 v12, 7, v12
    v_mul_u32_u24 v12, 576, v12
    v_add_u32 v12, v12, v13
    v_lshlrev_b32 v12, 3, v12
    v_sub_f32 v56, v96, v80
    v_mov_b32 v57, s48
    v_sub_f32 v58, v97, v81
    v_mov_b32 v59, s48
    global_store_dwordx4 v12, v[56:59], s[64:65] sc1
L_t1i_28:
    s_mov_b64 exec, s[66:67]
    v_bfe_u32 v12, v48, 8, 8
    v_cmp_lt_u32 vcc, 0x7f, v12
    s_and_saveexec_b64 s[66:67], vcc
    s_cbranch_execz L_t1i_29
    v_and_b32 v12, 7, v12
    v_mul_u32_u24 v12, 576, v12
    v_add_u32 v12, v12, v13
    v_lshlrev_b32 v12, 3, v12
    v_sub_f32 v56, v98, v82
    v_mov_b32 v57, s48
    v_sub_f32 v58, v99, v83
    v_mov_b32 v59, s48
    global_store_dwordx4 v12, v[56:59], s[64:65] sc1
L_t1i_29:
    s_mov_b64 exec, s[66:67]
    v_bfe_u32 v12, v48, 16, 8
    v_cmp_lt_u32 vcc, 0x7f, v12
    s_and_saveexec_b64 s[66:67], vcc
    s_cbranch_execz L_t1i_30
    v_and_b32 v12, 7, v12
    v_mul_u32_u24 v12, 576, v12
    v_add_u32 v12, v12, v13
    v_lshlrev_b32 v12, 3, v12
    v_sub_f32 v56, v100, v84
    v_mov_b32 v57, s48
    v_sub_f32 v58, v101, v85
    v_mov_b32 v59, s48
    global_store_dwordx4 v12, v[56:59], s[64:65] sc1
L_t1i_30:
    s_mov_b64 exec, s[66:67]
    v_bfe_u32 v12, v48, 24, 8
    v_cmp_lt_u32 vcc, 0x7f, v12
    s_and_saveexec_b64 s[66:67], vcc
    s_cbranch_execz L_t1i_31
    v_and_b32 v12, 7, v12
    v_mul_u32_u24 v12, 576, v12
    v_add_u32 v12, v12, v13
    v_lshlrev_b32 v12, 3, v12
    v_sub_f32 v56, v102, v86
    v_mov_b32 v57, s48
    v_sub_f32 v58, v103, v87
    v_mov_b32 v59, s48
    global_store_dwordx4 v12, v[56:59], s[64:65] sc1
L_t1i_31:
    s_mov_b64 exec, s[66:67]
    v_bfe_u32 v12, v49, 0, 8
    v_cmp_lt_u32 vcc, 0x7f, v12
    s_and_saveexec_b64 s[66:67], vcc
    s_cbranch_execz L_t1i_32
    v_and_b32 v12, 7, v12
    v_mul_u32_u24 v12, 576, v12
    v_add_u32 v12, v12, v13
    v_lshlrev_b32 v12, 3, v12
    v_sub_f32 v56, v104, v88
    v_mov_b32 v57, s48
    v_sub_f32 v58, v105, v89
    v_mov_b32 v59, s48
    global_store_dwordx4 v12, v[56:59], s[64:65] sc1
L_t1i_32:
    s_mov_b64 exec, s[66:67]
    v_bfe_u32 v12, v49, 8, 8
    v_cmp_lt_u32 vcc, 0x7f, v12
    s_and_saveexec_b64 s[66:67], vcc
    s_cbranch_execz L_t1i_33
    v_and_b32 v12, 7, v12
    v_mul_u32_u24 v12, 576, v12
    v_add_u32 v12, v12, v13
    v_lshlrev_b32 v12, 3, v12
    v_sub_f32 v56, v106, v90
    v_mov_b32 v57, s48
    v_sub_f32 v58, v107, v91
    v_mov_b32 v59, s48
    global_store_dwordx4 v12, v[56:59], s[64:65] sc1
L_t1i_33:
    s_mov_b64 exec, s[66:67]
    v_bfe_u32 v12, v49, 16, 8
    v_cmp_lt_u32 vcc, 0x7f, v12
    s_and_saveexec_b64 s[66:67], vcc
    s_cbranch_execz L_t1i_34
    v_and_b32 v12, 7, v12
    v_mul_u32_u24 v12, 576, v12
    v_add_u32 v12, v12, v13
    v_lshlrev_b32 v12, 3, v12
    v_sub_f32 v56, v108, v92
    v_mov_b32 v57, s48
    v_sub_f32 v58, v109, v93
    v_mov_b32 v59, s48
    global_store_dwordx4 v12, v[56:59], s[64:65] sc1
L_t1i_34:
    s_mov_b64 exec, s[66:67]
    v_bfe_u32 v12, v49, 24, 8
    v_cmp_lt_u32 vcc, 0x7f, v12
    s_and_saveexec_b64 s[66:67], vcc
    s_cbranch_execz L_t1i_35
    v_and_b32 v12, 7, v12
    v_mul_u32_u24 v12, 576, v12
    v_add_u32 v12, v12, v13
    v_lshlrev_b32 v12, 3, v12
    v_sub_f32 v56, v110, v94
    v_mov_b32 v57, s48
    v_sub_f32 v58, v111, v95
    v_mov_b32 v59, s48
    global_store_dwordx4 v12, v[56:59], s[64:65] sc1
L_t1i_35:
    s_mov_b64 exec, s[66:67]
L_nt1_27:
    s_waitcnt lgkmcnt(0)
    s_barrier
    ds_read_b128 v[16:19], v121
    ds_read_b128 v[20:23], v121 offset:8320
    s_waitcnt lgkmcnt(1)
    buffer_store_dwordx4 v[16:19], v122, s[44:47], 0 offen sc1
    s_waitcnt lgkmcnt(0)
    buffer_store_dwordx4 v[20:23], v123, s[44:47], 0 offen sc1
    s_branch L_fin
L_moe:
    s_sub_u32 s69, s2, 144
    s_cmp_ge_u32 s69, 72
    s_cbranch_scc1 L_spare
    s_and_b32 s70, s69, 7
    s_mul_i32 s70, s70, 9
    s_lshr_b32 s55, s69, 3
    s_add_u32 s70, s70, s55
    s_cmp_ge_u32 s3, 4
    s_cbranch_scc1 L_mln_36
    s_lshl_b32 s68, s69, 4
    s_lshl_b32 s55, s3, 2
    s_add_u32 s68, s68, s55
    s_mov_b32 s54, s68
    v_lshrrev_b32 v1, 4, v0
    v_and_b32 v2, 15, v0
    v_add_u32 v3, s54, v1
    v_mul_u32_u24 v4, 1152, v3
    v_lshl_add_u32 v5, v2, 4, v4
    v_lshl_add_u32 v6, v2, 3, v4
    global_load_dwordx4 v[10:13], v5, s[4:5] offset:0
    global_load_dwordx4 v[14:17], v5, s[4:5] offset:256
    global_load_dwordx4 v[18:21], v5, s[4:5] offset:512
    global_load_dwordx4 v[22:25], v5, s[4:5] offset:768
    global_load_dwordx2 v[26:27], v6, s[4:5] offset:1024
    v_lshlrev_b32 v7, 4, v2
    v_lshlrev_b32 v8, 3, v2
    global_load_dwordx4 v[28:31], v7, s[18:19] offset:0
    global_load_dwordx4 v[32:35], v7, s[18:19] offset:256
    global_load_dwordx4 v[36:39], v7, s[18:19] offset:512
    global_load_dwordx4 v[40:43], v7, s[18:19] offset:768
    global_load_dwordx2 v[44:45], v8, s[18:19] offset:1024
    v_mov_b32 v120, 0
    global_load_dword v121, v120, s[28:29] sc1
    s_waitcnt vmcnt(1)
    s_mov_b32 s62, 0x3f803f80
    s_mov_b32 s63, 0x00003f80
    s_mov_b32 s64, 0x3f800000
    v_mov_b32 v64, 0
    v_mov_b32 v65, 0
    v_mov_b32 v66, 0
    v_mov_b32 v67, 0
    v_mov_b32 v68, 0
    v_mov_b32 v69, 0
    v_dot2_f32_bf16 v64, v10, s62, v64
    v_dot2_f32_bf16 v66, v10, v28, v66
    v_dot2_f32_bf16 v68, v28, s62, v68
    v_dot2_f32_bf16 v65, v11, s62, v65
    v_dot2_f32_bf16 v67, v11, v29, v67
    v_dot2_f32_bf16 v69, v29, s62, v69
    v_dot2_f32_bf16 v64, v12, s62, v64
    v_dot2_f32_bf16 v66, v12, v30, v66
    v_dot2_f32_bf16 v68, v30, s62, v68
    v_dot2_f32_bf16 v65, v13, s62, v65
    v_dot2_f32_bf16 v67, v13, v31, v67
    v_dot2_f32_bf16 v69, v31, s62, v69
    v_dot2_f32_bf16 v64, v14, s62, v64
    v_dot2_f32_bf16 v66, v14, v32, v66
    v_dot2_f32_bf16 v68, v32, s62, v68
    v_dot2_f32_bf16 v65, v15, s62, v65
    v_dot2_f32_bf16 v67, v15, v33, v67
    v_dot2_f32_bf16 v69, v33, s62, v69
    v_dot2_f32_bf16 v64, v16, s62, v64
    v_dot2_f32_bf16 v66, v16, v34, v66
    v_dot2_f32_bf16 v68, v34, s62, v68
    v_dot2_f32_bf16 v65, v17, s62, v65
    v_dot2_f32_bf16 v67, v17, v35, v67
    v_dot2_f32_bf16 v69, v35, s62, v69
    v_dot2_f32_bf16 v64, v18, s62, v64
    v_dot2_f32_bf16 v66, v18, v36, v66
    v_dot2_f32_bf16 v68, v36, s62, v68
    v_dot2_f32_bf16 v65, v19, s62, v65
    v_dot2_f32_bf16 v67, v19, v37, v67
    v_dot2_f32_bf16 v69, v37, s62, v69
    v_dot2_f32_bf16 v64, v20, s62, v64
    v_dot2_f32_bf16 v66, v20, v38, v66
    v_dot2_f32_bf16 v68, v38, s62, v68
    v_dot2_f32_bf16 v65, v21, s62, v65
    v_dot2_f32_bf16 v67, v21, v39, v67
    v_dot2_f32_bf16 v69, v39, s62, v69
    v_dot2_f32_bf16 v64, v22, s62, v64
    v_dot2_f32_bf16 v66, v22, v40, v66
    v_dot2_f32_bf16 v68, v40, s62, v68
    v_dot2_f32_bf16 v65, v23, s62, v65
    v_dot2_f32_bf16 v67, v23, v41, v67
    v_dot2_f32_bf16 v69, v41, s62, v69
    v_dot2_f32_bf16 v64, v24, s62, v64
    v_dot2_f32_bf16 v66, v24, v42, v66
    v_dot2_f32_bf16 v68, v42, s62, v68
    v_dot2_f32_bf16 v65, v25, s62, v65
    v_dot2_f32_bf16 v67, v25, v43, v67
    v_dot2_f32_bf16 v69, v43, s62, v69
    v_dot2_f32_bf16 v64, v26, s62, v64
    v_dot2_f32_bf16 v66, v26, v44, v66
    v_dot2_f32_bf16 v68, v44, s62, v68
    v_dot2_f32_bf16 v65, v27, s62, v65
    v_dot2_f32_bf16 v67, v27, v45, v67
    v_dot2_f32_bf16 v69, v45, s62, v69
    s_nop 2
    v_add_f32 v64, v64, v65
    v_add_f32 v66, v66, v67
    v_add_f32 v122, v68, v69
    s_nop 0
    v_add_f32_dpp v64, v64, v64 row_ror:8 row_mask:0xf bank_mask:0xf
    v_add_f32_dpp v66, v66, v66 row_ror:8 row_mask:0xf bank_mask:0xf
    v_add_f32_dpp v122, v122, v122 row_ror:8 row_mask:0xf bank_mask:0xf
    v_add_f32_dpp v64, v64, v64 row_ror:4 row_mask:0xf bank_mask:0xf
    v_add_f32_dpp v66, v66, v66 row_ror:4 row_mask:0xf bank_mask:0xf
    v_add_f32_dpp v122, v122, v122 row_ror:4 row_mask:0xf bank_mask:0xf
    v_add_f32_dpp v64, v64, v64 row_ror:2 row_mask:0xf bank_mask:0xf
    v_add_f32_dpp v66, v66, v66 row_ror:2 row_mask:0xf bank_mask:0xf
    v_add_f32_dpp v122, v122, v122 row_ror:2 row_mask:0xf bank_mask:0xf
    v_add_f32_dpp v64, v64, v64 row_ror:1 row_mask:0xf bank_mask:0xf
    v_add_f32_dpp v66, v66, v66 row_ror:1 row_mask:0xf bank_mask:0xf
    v_add_f32_dpp v122, v122, v122 row_ror:1 row_mask:0xf bank_mask:0xf
    v_mul_f32 v64, 0x3ae38e39, v64
    v_sub_f32 v65, 0, v64
    v_mov_b32 v68, 0
    v_mov_b32 v69, 0
    v_mov_b32 v70, 0
    v_mov_b32 v71, 0
    v_dot2_f32_bf16 v72, v10, s63, v65
    v_dot2_f32_bf16 v73, v10, s64, v65
    v_dot2_f32_bf16 v74, v11, s63, v65
    v_dot2_f32_bf16 v75, v11, s64, v65
    s_nop 1
    v_fma_f32 v68, v72, v72, v68
    v_fma_f32 v69, v73, v73, v69
    v_fma_f32 v70, v74, v74, v70
    v_fma_f32 v71, v75, v75, v71
    v_dot2_f32_bf16 v72, v12, s63, v65
    v_dot2_f32_bf16 v73, v12, s64, v65
    v_dot2_f32_bf16 v74, v13, s63, v65
    v_dot2_f32_bf16 v75, v13, s64, v65
    s_nop 1
    v_fma_f32 v68, v72, v72, v68
    v_fma_f32 v69, v73, v73, v69
    v_fma_f32 v70, v74, v74, v70
    v_fma_f32 v71, v75, v75, v71
    v_dot2_f32_bf16 v72, v14, s63, v65
    v_dot2_f32_bf16 v73, v14, s64, v65
    v_dot2_f32_bf16 v74, v15, s63, v65
    v_dot2_f32_bf16 v75, v15, s64, v65
    s_nop 1
    v_fma_f32 v68, v72, v72, v68
    v_fma_f32 v69, v73, v73, v69
    v_fma_f32 v70, v74, v74, v70
    v_fma_f32 v71, v75, v75, v71
    v_dot2_f32_bf16 v72, v16, s63, v65
    v_dot2_f32_bf16 v73, v16, s64, v65
    v_dot2_f32_bf16 v74, v17, s63, v65
    v_dot2_f32_bf16 v75, v17, s64, v65
    s_nop 1
    v_fma_f32 v68, v72, v72, v68
    v_fma_f32 v69, v73, v73, v69
    v_fma_f32 v70, v74, v74, v70
    v_fma_f32 v71, v75, v75, v71
    v_dot2_f32_bf16 v72, v18, s63, v65
    v_dot2_f32_bf16 v73, v18, s64, v65
    v_dot2_f32_bf16 v74, v19, s63, v65
    v_dot2_f32_bf16 v75, v19, s64, v65
    s_nop 1
    v_fma_f32 v68, v72, v72, v68
    v_fma_f32 v69, v73, v73, v69
    v_fma_f32 v70, v74, v74, v70
    v_fma_f32 v71, v75, v75, v71
    v_dot2_f32_bf16 v72, v20, s63, v65
    v_dot2_f32_bf16 v73, v20, s64, v65
    v_dot2_f32_bf16 v74, v21, s63, v65
    v_dot2_f32_bf16 v75, v21, s64, v65
    s_nop 1
    v_fma_f32 v68, v72, v72, v68
    v_fma_f32 v69, v73, v73, v69
    v_fma_f32 v70, v74, v74, v70
    v_fma_f32 v71, v75, v75, v71
    v_dot2_f32_bf16 v72, v22, s63, v65
    v_dot2_f32_bf16 v73, v22, s64, v65
    v_dot2_f32_bf16 v74, v23, s63, v65
    v_dot2_f32_bf16 v75, v23, s64, v65
    s_nop 1
    v_fma_f32 v68, v72, v72, v68
    v_fma_f32 v69, v73, v73, v69
    v_fma_f32 v70, v74, v74, v70
    v_fma_f32 v71, v75, v75, v71
    v_dot2_f32_bf16 v72, v24, s63, v65
    v_dot2_f32_bf16 v73, v24, s64, v65
    v_dot2_f32_bf16 v74, v25, s63, v65
    v_dot2_f32_bf16 v75, v25, s64, v65
    s_nop 1
    v_fma_f32 v68, v72, v72, v68
    v_fma_f32 v69, v73, v73, v69
    v_fma_f32 v70, v74, v74, v70
    v_fma_f32 v71, v75, v75, v71
    v_dot2_f32_bf16 v72, v26, s63, v65
    v_dot2_f32_bf16 v73, v26, s64, v65
    v_dot2_f32_bf16 v74, v27, s63, v65
    v_dot2_f32_bf16 v75, v27, s64, v65
    s_nop 1
    v_fma_f32 v68, v72, v72, v68
    v_fma_f32 v69, v73, v73, v69
    v_fma_f32 v70, v74, v74, v70
    v_fma_f32 v71, v75, v75, v71
    v_add_f32 v68, v68, v69
    v_add_f32 v70, v70, v71
    v_add_f32 v68, v68, v70
    s_nop 1
    v_add_f32_dpp v68, v68, v68 row_ror:8 row_mask:0xf bank_mask:0xf
    s_nop 1
    v_add_f32_dpp v68, v68, v68 row_ror:4 row_mask:0xf bank_mask:0xf
    s_nop 1
    v_add_f32_dpp v68, v68, v68 row_ror:2 row_mask:0xf bank_mask:0xf
    s_nop 1
    v_add_f32_dpp v68, v68, v68 row_ror:1 row_mask:0xf bank_mask:0xf
    v_mul_f32 v68, 0x3ae38e39, v68
    v_cvt_pk_bf16_f32 v68, 0, v68
    v_add_f32 v68, 0x3727c5ac, v68
    v_cvt_pk_bf16_f32 v68, 0, v68
    v_sqrt_f32 v69, v68
    s_nop 0
    v_rcp_f32 v70, v69
    v_fma_f32 v71, -v69, v69, v68
    v_mul_f32 v70, 0.5, v70
    v_fma_f32 v69, v71, v70, v69
    v_cvt_pk_bf16_f32 v69, 0, v69
    v_rcp_f32 v70, v69
    v_cvt_pk_bf16_f32 v64, 0, v64
    v_fma_f32 v66, -v64, v122, v66
    v_mul_f32 v112, v66, v70
    v_cvt_pk_bf16_f32 v112, 0, v112
    v_xor_b32 v113, 0x7ff, v3
    v_or_b32 v112, v112, v113
    v_cvt_pk_bf16_f32 v114, v64, v69
    s_waitcnt vmcnt(0)
    v_readfirstlane_b32 s48, v121
    s_cmp_lg_u32 s48, 0
    s_cbranch_scc1 L_lnn_37
    v_mov_b32 v124, 0
    s_mov_b32 s54, 0
L_nonce_38:
    global_load_dword v125, v124, s[28:29] sc1
    s_waitcnt vmcnt(0)
    v_readfirstlane_b32 s48, v125
    s_add_u32 s54, s54, 1
    s_cmp_lg_u32 s48, 0
    s_cbranch_scc1 L_nonced_39
    s_cmp_lt_u32 s54, 400000
    s_cbranch_scc1 L_nonce_38
L_nonced_39:
L_lnn_37:
    v_mov_b32 v113, s48
    v_mov_b32 v115, s48
    v_lshlrev_b32 v116, 3, v3
    s_add_u32 s56, s30, 4718592
    s_addc_u32 s57, s31, 0
    s_add_u32 s58, s30, 4734976
    s_addc_u32 s59, s31, 0
    v_cmp_eq_u32 vcc, 0, v2
    s_and_saveexec_b64 s[60:61], vcc
    global_store_dwordx2 v116, v[112:113], s[56:57] sc1
    global_store_dwordx2 v116, v[114:115], s[58:59] sc1
    s_mov_b64 exec, s[60:61]
L_mln_36:
    s_mov_b32 s32, s20
    s_and_b32 s33, s21, 0xffff
    s_mov_b32 s34, 5308416
    s_mov_b32 s35, 0x00020000
    s_mov_b32 s36, s22
    s_and_b32 s37, s23, 0xffff
    s_mov_b32 s38, 5308416
    s_mov_b32 s39, 0x00020000
    v_lshrrev_b32 v1, 3, v0
    v_and_b32 v2, 7, v0
    v_bfe_u32 v3, v0, 4, 1
    s_and_b32 s55, s3, 1
    s_lshl_b32 s55, s55, 1
    v_add_u32 v3, s55, v3
    v_lshlrev_b32 v3, 1, v3
    v_xor_b32 v2, v2, v3
    v_mul_u32_u24 v1, 9216, v1
    v_lshl_add_u32 v1, v2, 4, v1
    s_lshl_b32 s55, s70, 7
    v_add_u32 v1, s55, v1
    s_mul_i32 s57, s3, 73728
    s_lshl_b32 s58, s3, 10
    s_mov_b32 s59, 0
L_dma_40:
    s_add_u32 m0, s58, 0
    s_nop 0
    buffer_load_dwordx4 v1, s[32:35], s57 offen nt lds
    s_add_u32 m0, s58, 73728
    s_add_u32 s59, s59, 1
    buffer_load_dwordx4 v1, s[36:39], s57 offen nt lds
    s_add_u32 s57, s57, 589824
    s_add_u32 s58, s58, 8192
    s_cmp_lt_u32 s59, 9
    s_cbranch_scc1 L_dma_40
    s_waitcnt vmcnt(4)
    s_lshl_b32 s55, s3, 3
    s_add_u32 s55, s55, 4757504
    v_mov_b32 v3, s55
    v_mov_b32 v4, 0
    s_mov_b32 s54, 0
L_sw_41:
    global_load_dwordx2 v[16:17], v3, s[30:31] sc1
    global_load_dword v30, v4, s[28:29] sc1
    s_waitcnt vmcnt(0)
    v_readfirstlane_b32 s48, v30
    v_readfirstlane_b32 s56, v17
    s_add_u32 s54, s54, 1
    s_cmp_ge_u32 s54, 400000
    s_cbranch_scc1 L_swd_42
    s_cmp_eq_u32 s48, 0
    s_cbranch_scc1 L_sw_41_s
    s_cmp_eq_u32 s56, s48
    s_cbranch_scc1 L_swd_42
L_sw_41_s:
    s_sleep 3
    s_branch L_sw_41
L_swd_42:
    v_and_b32 v18, 0x7ff, v16
    v_xor_b32 v18, 0x7ff, v18
    v_mul_u32_u24 v20, 1152, v18
    v_and_b32 v21, 31, v0
    v_mul_u32_u24 v21, 36, v21
    v_add_u32 v20, v20, v21
    global_load_dwordx4 v[24:27], v20, s[4:5]
    global_load_dwordx4 v[28:31], v20, s[4:5] offset:16
    global_load_dword v32, v20, s[4:5] offset:32
    v_lshlrev_b32 v22, 3, v18
    v_add_u32 v22, 4734976, v22
    global_load_dwordx2 v[40:41], v22, s[30:31] sc1
    s_barrier
    v_lshrrev_b32 v6, 4, v0
    v_mul_u32_u24 v5, 9216, v6
    v_and_b32 v6, 15, v0
    v_lshl_add_u32 v5, v6, 3, v5
    s_mul_i32 s55, s70, 73728
    s_lshl_b32 s56, s3, 7
    s_add_u32 s55, s55, s56
    v_add_u32 v5, s55, v5
    s_mov_b32 s40, s24
    s_and_b32 s41, s25, 0xffff
    s_mov_b32 s42, 5308416
    s_mov_b32 s43, 0x00020000
    s_mov_b32 s57, 0
    buffer_load_dwordx2 v[64:65], v5, s[40:43], s57 offen offset:0 nt
    s_mov_b32 s57, 0
    buffer_load_dwordx2 v[66:67], v5, s[40:43], s57 offen offset:1152 nt
    s_mov_b32 s57, 0
    buffer_load_dwordx2 v[68:69], v5, s[40:43], s57 offen offset:2304 nt
    s_mov_b32 s57, 0
    buffer_load_dwordx2 v[70:71], v5, s[40:43], s57 offen offset:3456 nt
    s_mov_b32 s57, 4608
    buffer_load_dwordx2 v[72:73], v5, s[40:43], s57 offen offset:0 nt
    s_mov_b32 s57, 4608
    buffer_load_dwordx2 v[74:75], v5, s[40:43], s57 offen offset:1152 nt
    s_mov_b32 s57, 4608
    buffer_load_dwordx2 v[76:77], v5, s[40:43], s57 offen offset:2304 nt
    s_mov_b32 s57, 4608
    buffer_load_dwordx2 v[78:79], v5, s[40:43], s57 offen offset:3456 nt
    s_mov_b32 s57, 36864
    buffer_load_dwordx2 v[80:81], v5, s[40:43], s57 offen offset:0 nt
    s_mov_b32 s57, 36864
    buffer_load_dwordx2 v[82:83], v5, s[40:43], s57 offen offset:1152 nt
    s_mov_b32 s57, 36864
    buffer_load_dwordx2 v[84:85], v5, s[40:43], s57 offen offset:2304 nt
    s_mov_b32 s57, 36864
    buffer_load_dwordx2 v[86:87], v5, s[40:43], s57 offen offset:3456 nt
    s_mov_b32 s57, 41472
    buffer_load_dwordx2 v[88:89], v5, s[40:43], s57 offen offset:0 nt
    s_mov_b32 s57, 41472
    buffer_load_dwordx2 v[90:91], v5, s[40:43], s57 offen offset:1152 nt
    s_mov_b32 s57, 41472
    buffer_load_dwordx2 v[92:93], v5, s[40:43], s57 offen offset:2304 nt
    s_mov_b32 s57, 41472
    buffer_load_dwordx2 v[94:95], v5, s[40:43], s57 offen offset:3456 nt
    s_cmp_lg_u32 s3, 0
    s_cbranch_scc1 L_np8_43
    s_mov_b32 s57, 1024
    buffer_load_dwordx2 v[96:97], v5, s[40:43], s57 offen offset:0 nt
    s_mov_b32 s57, 1024
    buffer_load_dwordx2 v[98:99], v5, s[40:43], s57 offen offset:1152 nt
    s_mov_b32 s57, 1024
    buffer_load_dwordx2 v[100:101], v5, s[40:43], s57 offen offset:2304 nt
    s_mov_b32 s57, 1024
    buffer_load_dwordx2 v[102:103], v5, s[40:43], s57 offen offset:3456 nt
    s_mov_b32 s57, 5632
    buffer_load_dwordx2 v[104:105], v5, s[40:43], s57 offen offset:0 nt
    s_mov_b32 s57, 5632
    buffer_load_dwordx2 v[106:107], v5, s[40:43], s57 offen offset:1152 nt
    s_mov_b32 s57, 5632
    buffer_load_dwordx2 v[108:109], v5, s[40:43], s57 offen offset:2304 nt
    s_mov_b32 s57, 5632
    buffer_load_dwordx2 v[110:111], v5, s[40:43], s57 offen offset:3456 nt
    s_mov_b32 s57, 37888
    buffer_load_dwordx2 v[112:113], v5, s[40:43], s57 offen offset:0 nt
    s_mov_b32 s57, 37888
    buffer_load_dwordx2 v[114:115], v5, s[40:43], s57 offen offset:1152 nt
    s_mov_b32 s57, 37888
    buffer_load_dwordx2 v[116:117], v5, s[40:43], s57 offen offset:2304 nt
    s_mov_b32 s57, 37888
    buffer_load_dwordx2 v[118:119], v5, s[40:43], s57 offen offset:3456 nt
    s_mov_b32 s57, 42496
    buffer_load_dwordx2 v[120:121], v5, s[40:43], s57 offen offset:0 nt
    s_mov_b32 s57, 42496
    buffer_load_dwordx2 v[122:123], v5, s[40:43], s57 offen offset:1152 nt
    s_mov_b32 s57, 42496
    buffer_load_dwordx2 v[124:125], v5, s[40:43], s57 offen offset:2304 nt
    s_mov_b32 s57, 42496
    buffer_load_dwordx2 v[126:127], v5, s[40:43], s57 offen offset:3456 nt
L_np8_43:
    s_lshr_b32 s55, s3, 2
    s_and_b32 s56, s3, 3
    v_lshrrev_b32 v6, 4, v0
    v_bfe_u32 v7, v0, 2, 2
    v_and_b32 v8, 3, v0
    v_lshrrev_b32 v9, 1, v7
    v_and_b32 v10, 1, v6
    v_lshl_add_u32 v9, v10, 1, v9
    v_lshlrev_b32 v9, 1, v9
    v_lshrrev_b32 v10, 1, v8
    s_lshl_b32 s57, s56, 1
    v_add_u32 v10, s57, v10
    v_xor_b32 v10, v10, v9
    v_lshlrev_b32 v34, 10, v6
    v_lshl_add_u32 v34, v7, 7, v34
    v_lshl_add_u32 v34, v10, 4, v34
    v_and_b32 v8, 1, v8
    v_lshl_add_u32 v34, v8, 3, v34
    s_mul_i32 s57, s55, 73728
    v_add_u32 v34, s57, v34
    v_add_u32 v35, 36864, v34
    ds_read_b64_tr_b16 v[128:129], v34 offset:0
    ds_read_b64_tr_b16 v[130:131], v34 offset:512
    ds_read_b64_tr_b16 v[132:133], v34 offset:4096
    ds_read_b64_tr_b16 v[134:135], v34 offset:4608
    ds_read_b64_tr_b16 v[136:137], v34 offset:8192
    ds_read_b64_tr_b16 v[138:139], v34 offset:8704
    ds_read_b64_tr_b16 v[140:141], v34 offset:12288
    ds_read_b64_tr_b16 v[142:143], v34 offset:12800
    ds_read_b64_tr_b16 v[144:145], v34 offset:16384
    ds_read_b64_tr_b16 v[146:147], v34 offset:16896
    ds_read_b64_tr_b16 v[148:149], v34 offset:20480
    ds_read_b64_tr_b16 v[150:151], v34 offset:20992
    s_waitcnt lgkmcnt(2)
    ds_read_b64_tr_b16 v[152:153], v34 offset:24576
    ds_read_b64_tr_b16 v[154:155], v34 offset:25088
    ds_read_b64_tr_b16 v[156:157], v34 offset:28672
    ds_read_b64_tr_b16 v[158:159], v34 offset:29184
    ds_read_b64_tr_b16 v[160:161], v34 offset:32768
    ds_read_b64_tr_b16 v[162:163], v34 offset:33280
    ds_read_b64_tr_b16 v[164:165], v35 offset:0
    ds_read_b64_tr_b16 v[166:167], v35 offset:512
    ds_read_b64_tr_b16 v[168:169], v35 offset:4096
    ds_read_b64_tr_b16 v[170:171], v35 offset:4608
    ds_read_b64_tr_b16 v[172:173], v35 offset:8192
    ds_read_b64_tr_b16 v[174:175], v35 offset:8704
    s_waitcnt lgkmcnt(2)
    ds_read_b64_tr_b16 v[176:177], v35 offset:12288
    ds_read_b64_tr_b16 v[178:179], v35 offset:12800
    ds_read_b64_tr_b16 v[180:181], v35 offset:16384
    ds_read_b64_tr_b16 v[182:183], v35 offset:16896
    ds_read_b64_tr_b16 v[184:185], v35 offset:20480
    ds_read_b64_tr_b16 v[186:187], v35 offset:20992
    ds_read_b64_tr_b16 v[188:189], v35 offset:24576
    ds_read_b64_tr_b16 v[190:191], v35 offset:25088
    ds_read_b64_tr_b16 a[0:1], v35 offset:28672
    ds_read_b64_tr_b16 a[2:3], v35 offset:29184
    ds_read_b64_tr_b16 a[4:5], v35 offset:32768
    ds_read_b64_tr_b16 a[6:7], v35 offset:33280
    s_waitcnt lgkmcnt(2)
    s_cmp_lg_u32 s3, 0
    s_cbranch_scc1 L_w32_44
    s_waitcnt vmcnt(32)
L_w32_44:
    s_cmp_eq_u32 s3, 0
    s_cbranch_scc1 L_w32_44_b
    s_waitcnt vmcnt(16)
L_w32_44_b:
    s_mov_b32 s54, 0
L_sg_45:
    v_readfirstlane_b32 s56, v41
    s_add_u32 s54, s54, 1
    s_cmp_eq_u32 s56, s48
    s_cbranch_scc1 L_sgd_46
    s_cmp_ge_u32 s54, 400000
    s_cbranch_scc1 L_sgd_46
    global_load_dwordx2 v[40:41], v22, s[30:31] sc1
    s_waitcnt vmcnt(0)
    s_branch L_sg_45
L_sgd_46:
    v_lshlrev_b32 v44, 16, v40
    v_and_b32 v45, s50, v40
    v_rcp_f32 v46, v45
    v_and_b32 v52, s50, v16
    v_fma_f32 v47, -v45, v46, 1.0
    v_fma_f32 v46, v47, v46, v46
    v_mul_f32 v52, 0xbfb8aa3b, v52
    v_exp_f32 v52, v52
    v_lshlrev_b32 v48, 16, v24
    v_and_b32 v49, s50, v24
    v_pk_add_f32 v[48:49], v[48:49], v[44:45] op_sel_hi:[1,0] neg_lo:[0,1] neg_hi:[0,1]
    v_cvt_pk_bf16_f32 v48, 0, v48
    v_cvt_pk_bf16_f32 v49, 0, v49
    v_pk_mul_f32 v[48:49], v[48:49], v[46:47] op_sel_hi:[1,0]
    v_cvt_pk_bf16_f32 v24, v48, v49
    v_lshlrev_b32 v50, 16, v25
    v_and_b32 v51, s50, v25
    v_pk_add_f32 v[50:51], v[50:51], v[44:45] op_sel_hi:[1,0] neg_lo:[0,1] neg_hi:[0,1]
    v_cvt_pk_bf16_f32 v50, 0, v50
    v_cvt_pk_bf16_f32 v51, 0, v51
    v_pk_mul_f32 v[50:51], v[50:51], v[46:47] op_sel_hi:[1,0]
    v_cvt_pk_bf16_f32 v25, v50, v51
    v_lshlrev_b32 v48, 16, v26
    v_and_b32 v49, s50, v26
    v_pk_add_f32 v[48:49], v[48:49], v[44:45] op_sel_hi:[1,0] neg_lo:[0,1] neg_hi:[0,1]
    v_cvt_pk_bf16_f32 v48, 0, v48
    v_cvt_pk_bf16_f32 v49, 0, v49
    v_pk_mul_f32 v[48:49], v[48:49], v[46:47] op_sel_hi:[1,0]
    v_cvt_pk_bf16_f32 v26, v48, v49
    v_lshlrev_b32 v50, 16, v27
    v_and_b32 v51, s50, v27
    v_pk_add_f32 v[50:51], v[50:51], v[44:45] op_sel_hi:[1,0] neg_lo:[0,1] neg_hi:[0,1]
    v_cvt_pk_bf16_f32 v50, 0, v50
    v_cvt_pk_bf16_f32 v51, 0, v51
    v_pk_mul_f32 v[50:51], v[50:51], v[46:47] op_sel_hi:[1,0]
    v_cvt_pk_bf16_f32 v27, v50, v51
    v_lshlrev_b32 v48, 16, v28
    v_and_b32 v49, s50, v28
    v_pk_add_f32 v[48:49], v[48:49], v[44:45] op_sel_hi:[1,0] neg_lo:[0,1] neg_hi:[0,1]
    v_cvt_pk_bf16_f32 v48, 0, v48
    v_cvt_pk_bf16_f32 v49, 0, v49
    v_pk_mul_f32 v[48:49], v[48:49], v[46:47] op_sel_hi:[1,0]
    v_cvt_pk_bf16_f32 v28, v48, v49
    v_lshlrev_b32 v50, 16, v29
    v_and_b32 v51, s50, v29
    v_pk_add_f32 v[50:51], v[50:51], v[44:45] op_sel_hi:[1,0] neg_lo:[0,1] neg_hi:[0,1]
    v_cvt_pk_bf16_f32 v50, 0, v50
    v_cvt_pk_bf16_f32 v51, 0, v51
    v_pk_mul_f32 v[50:51], v[50:51], v[46:47] op_sel_hi:[1,0]
    v_cvt_pk_bf16_f32 v29, v50, v51
    v_lshlrev_b32 v48, 16, v30
    v_and_b32 v49, s50, v30
    v_pk_add_f32 v[48:49], v[48:49], v[44:45] op_sel_hi:[1,0] neg_lo:[0,1] neg_hi:[0,1]
    v_cvt_pk_bf16_f32 v48, 0, v48
    v_cvt_pk_bf16_f32 v49, 0, v49
    v_pk_mul_f32 v[48:49], v[48:49], v[46:47] op_sel_hi:[1,0]
    v_cvt_pk_bf16_f32 v30, v48, v49
    v_lshlrev_b32 v50, 16, v31
    v_and_b32 v51, s50, v31
    v_pk_add_f32 v[50:51], v[50:51], v[44:45] op_sel_hi:[1,0] neg_lo:[0,1] neg_hi:[0,1]
    v_cvt_pk_bf16_f32 v50, 0, v50
    v_cvt_pk_bf16_f32 v51, 0, v51
    v_pk_mul_f32 v[50:51], v[50:51], v[46:47] op_sel_hi:[1,0]
    v_cvt_pk_bf16_f32 v31, v50, v51
    v_lshlrev_b32 v48, 16, v32
    v_and_b32 v49, s50, v32
    v_pk_add_f32 v[48:49], v[48:49], v[44:45] op_sel_hi:[1,0] neg_lo:[0,1] neg_hi:[0,1]
    v_cvt_pk_bf16_f32 v48, 0, v48
    v_cvt_pk_bf16_f32 v49, 0, v49
    v_pk_mul_f32 v[48:49], v[48:49], v[46:47] op_sel_hi:[1,0]
    v_cvt_pk_bf16_f32 v32, v48, v49
    v_add_f32 v52, 1.0, v52
    v_rcp_f32 v52, v52
    s_mul_i32 s58, s3, 1168
    s_add_u32 s58, s58, 147456
    v_add_u32 v21, s58, v21
    v_cvt_pk_bf16_f32 v52, 0, v52
    s_mov_b64 exec, 0xffffffff
    ds_write2_b32 v21, v24, v25 offset0:0 offset1:1
    ds_write2_b32 v21, v26, v27 offset0:2 offset1:3
    ds_write2_b32 v21, v28, v29 offset0:4 offset1:5
    ds_write2_b32 v21, v30, v31 offset0:6 offset1:7
    ds_write_b32 v21, v32 offset:32
    s_lshl_b32 s58, s3, 2
    s_add_u32 s58, s58, 162080
    v_mov_b32 v53, s58
    s_mov_b64 exec, 1
    ds_write_b32 v53, v16
    ds_write_b32 v53, v52 offset:32
    s_mov_b64 exec, -1
    s_lshl_b32 s55, s3, 6
    v_add_u32 v1, s55, v0
    s_waitcnt lgkmcnt(0)
    s_barrier
    s_lshr_b32 s55, s3, 2
    s_and_b32 s56, s3, 3
    v_lshrrev_b32 v6, 4, v0
    v_and_b32 v3, 7, v0
    v_mul_u32_u24 v3, 1168, v3
    v_lshl_add_u32 v3, v6, 4, v3
    v_add_u32 v3, 147456, v3
    ds_read_b128 a[8:11], v3 offset:0
    ds_read_b128 a[12:15], v3 offset:64
    ds_read_b128 a[16:19], v3 offset:128
    ds_read_b128 a[20:23], v3 offset:192
    ds_read_b128 a[24:27], v3 offset:256
    ds_read_b128 a[28:31], v3 offset:320
    ds_read_b128 a[32:35], v3 offset:384
    ds_read_b128 a[36:39], v3 offset:448
    ds_read_b128 a[40:43], v3 offset:512
    ds_read_b128 a[44:47], v3 offset:576
    ds_read_b128 a[48:51], v3 offset:640
    ds_read_b128 a[52:55], v3 offset:704
    s_waitcnt lgkmcnt(11)
    v_mfma_f32_16x16x32_bf16 v[8:11], v[128:131], a[8:11], 0
    ds_read_b128 a[8:11], v3 offset:768
    s_waitcnt lgkmcnt(11)
    v_mfma_f32_16x16x32_bf16 v[12:15], v[132:135], a[12:15], 0
    ds_read_b128 a[12:15], v3 offset:832
    s_waitcnt lgkmcnt(11)
    v_mfma_f32_16x16x32_bf16 v[8:11], v[136:139], a[16:19], v[8:11]
    ds_read_b128 a[16:19], v3 offset:896
    s_waitcnt lgkmcnt(11)
    v_mfma_f32_16x16x32_bf16 v[12:15], v[140:143], a[20:23], v[12:15]
    ds_read_b128 a[20:23], v3 offset:960
    s_waitcnt lgkmcnt(11)
    v_mfma_f32_16x16x32_bf16 v[8:11], v[144:147], a[24:27], v[8:11]
    ds_read_b128 a[24:27], v3 offset:1024
    s_waitcnt lgkmcnt(11)
    v_mfma_f32_16x16x32_bf16 v[12:15], v[148:151], a[28:31], v[12:15]
    ds_read_b128 a[28:31], v3 offset:1088
    s_waitcnt lgkmcnt(11)
    v_mfma_f32_16x16x32_bf16 v[8:11], v[152:155], a[32:35], v[8:11]
    s_waitcnt lgkmcnt(10)
    v_mfma_f32_16x16x32_bf16 v[12:15], v[156:159], a[36:39], v[12:15]
    s_waitcnt lgkmcnt(9)
    v_mfma_f32_16x16x32_bf16 v[8:11], v[160:163], a[40:43], v[8:11]
    s_waitcnt lgkmcnt(8)
    v_mfma_f32_16x16x32_bf16 v[12:15], v[164:167], a[44:47], v[12:15]
    s_waitcnt lgkmcnt(7)
    v_mfma_f32_16x16x32_bf16 v[8:11], v[168:171], a[48:51], v[8:11]
    s_waitcnt lgkmcnt(6)
    v_mfma_f32_16x16x32_bf16 v[12:15], v[172:175], a[52:55], v[12:15]
    s_waitcnt lgkmcnt(5)
    v_mfma_f32_16x16x32_bf16 v[8:11], v[176:179], a[8:11], v[8:11]
    s_waitcnt lgkmcnt(4)
    v_mfma_f32_16x16x32_bf16 v[12:15], v[180:183], a[12:15], v[12:15]
    s_waitcnt lgkmcnt(3)
    v_mfma_f32_16x16x32_bf16 v[8:11], v[184:187], a[16:19], v[8:11]
    s_waitcnt lgkmcnt(2)
    v_mfma_f32_16x16x32_bf16 v[12:15], v[188:191], a[20:23], v[12:15]
    s_waitcnt lgkmcnt(1)
    v_mfma_f32_16x16x32_bf16 v[8:11], a[0:3], a[24:27], v[8:11]
    s_waitcnt lgkmcnt(0)
    v_mfma_f32_16x16x32_bf16 v[12:15], a[4:7], a[28:31], v[12:15]
    v_and_b32 v3, 15, v0
    v_lshlrev_b32 v4, 8, v3
    v_lshl_add_u32 v4, v6, 4, v4
    s_lshl_b32 s57, s55, 11
    s_lshl_b32 s58, s56, 6
    s_add_u32 s57, s57, s58
    s_add_u32 s57, s57, 157952
    v_add_u32 v4, s57, v4
    v_cmp_gt_u32 vcc, 8, v3
    s_and_saveexec_b64 s[66:67], vcc
    s_nop 1
    v_pk_add_f32 v[8:9], v[8:9], v[12:13]
    v_pk_add_f32 v[10:11], v[10:11], v[14:15]
    ds_write_b128 v4, v[8:11]
    s_mov_b64 exec, s[66:67]
    s_waitcnt lgkmcnt(0)
    s_barrier
    v_lshlrev_b32 v2, 2, v1
    v_add_u32 v2, 157952, v2
    ds_read_b32 v8, v2
    ds_read_b32 v9, v2 offset:2048
    v_lshrrev_b32 v3, 6, v1
    v_mul_u32_u24 v3, 144, v3
    v_lshl_add_u32 v3, v0, 1, v3
    v_add_u32 v3, 156800, v3
    s_waitcnt lgkmcnt(0)
    v_cvt_pk_bf16_f32 v8, 0, v8
    v_cvt_pk_bf16_f32 v9, 0, v9
    v_mul_f32 v10, 0xbfb8aa3b, v8
    v_exp_f32 v10, v10
    s_nop 0
    v_add_f32 v10, 1.0, v10
    v_rcp_f32 v10, v10
    s_nop 0
    v_mul_f32 v10, v8, v10
    v_cvt_pk_bf16_f32 v10, 0, v10
    v_mul_f32 v10, v10, v9
    v_cvt_pk_bf16_f32 v10, v10, v10
    ds_write_b16 v3, v10
    s_waitcnt vmcnt(0)
    v_perm_b32 v32, v66, v64, s51
    v_perm_b32 v33, v70, v68, s51
    v_perm_b32 v34, v74, v72, s51
    v_perm_b32 v35, v78, v76, s51
    v_perm_b32 v36, v66, v64, s52
    v_perm_b32 v37, v70, v68, s52
    v_perm_b32 v38, v74, v72, s52
    v_perm_b32 v39, v78, v76, s52
    v_perm_b32 v40, v67, v65, s51
    v_perm_b32 v41, v71, v69, s51
    v_perm_b32 v42, v75, v73, s51
    v_perm_b32 v43, v79, v77, s51
    v_perm_b32 v44, v67, v65, s52
    v_perm_b32 v45, v71, v69, s52
    v_perm_b32 v46, v75, v73, s52
    v_perm_b32 v47, v79, v77, s52
    v_perm_b32 v48, v82, v80, s51
    v_perm_b32 v49, v86, v84, s51
    v_perm_b32 v50, v90, v88, s51
    v_perm_b32 v51, v94, v92, s51
    v_perm_b32 v52, v82, v80, s52
    v_perm_b32 v53, v86, v84, s52
    v_perm_b32 v54, v90, v88, s52
    v_perm_b32 v55, v94, v92, s52
    v_perm_b32 v56, v83, v81, s51
    v_perm_b32 v57, v87, v85, s51
    v_perm_b32 v58, v91, v89, s51
    v_perm_b32 v59, v95, v93, s51
    v_perm_b32 v60, v83, v81, s52
    v_perm_b32 v61, v87, v85, s52
    v_perm_b32 v62, v91, v89, s52
    v_perm_b32 v63, v95, v93, s52
    s_cmp_lg_u32 s3, 0
    s_cbranch_scc1 L_np8b_47
    v_perm_b32 v64, v98, v96, s51
    v_perm_b32 v65, v102, v100, s51
    v_perm_b32 v66, v106, v104, s51
    v_perm_b32 v67, v110, v108, s51
    v_perm_b32 v68, v98, v96, s52
    v_perm_b32 v69, v102, v100, s52
    v_perm_b32 v70, v106, v104, s52
    v_perm_b32 v71, v110, v108, s52
    v_perm_b32 v72, v99, v97, s51
    v_perm_b32 v73, v103, v101, s51
    v_perm_b32 v74, v107, v105, s51
    v_perm_b32 v75, v111, v109, s51
    v_perm_b32 v76, v99, v97, s52
    v_perm_b32 v77, v103, v101, s52
    v_perm_b32 v78, v107, v105, s52
    v_perm_b32 v79, v111, v109, s52
    v_perm_b32 v80, v114, v112, s51
    v_perm_b32 v81, v118, v116, s51
    v_perm_b32 v82, v122, v120, s51
    v_perm_b32 v83, v126, v124, s51
    v_perm_b32 v84, v114, v112, s52
    v_perm_b32 v85, v118, v116, s52
    v_perm_b32 v86, v122, v120, s52
    v_perm_b32 v87, v126, v124, s52
    v_perm_b32 v88, v115, v113, s51
    v_perm_b32 v89, v119, v117, s51
    v_perm_b32 v90, v123, v121, s51
    v_perm_b32 v91, v127, v125, s51
    v_perm_b32 v92, v115, v113, s52
    v_perm_b32 v93, v119, v117, s52
    v_perm_b32 v94, v123, v121, s52
    v_perm_b32 v95, v127, v125, s52
L_np8b_47:
    s_waitcnt lgkmcnt(0)
    s_barrier
    v_and_b32 v2, 7, v0
    v_mul_u32_u24 v2, 144, v2
    v_lshrrev_b32 v6, 4, v0
    v_lshl_add_u32 v2, v6, 4, v2
    v_add_u32 v2, 156800, v2
    ds_read_b128 v[16:19], v2
    ds_read_b128 v[20:23], v2 offset:64
    v_and_b32 v4, 15, v0
    v_lshlrev_b32 v5, 4, v4
    v_lshl_add_u32 v5, v6, 9, v5
    s_mul_i32 s55, s70, 18432
    s_lshl_b32 s56, s3, 11
    s_add_u32 s55, s55, s56
    v_add_u32 v5, s55, v5
    s_add_u32 s56, s30, 4849664
    s_addc_u32 s57, s31, 0
    s_mov_b32 s58, 0x07060503
    s_mov_b32 s59, 0x06050302
    s_mov_b32 s60, 0x05030201
    v_cmp_gt_u32 vcc, 8, v4
    s_mov_b64 s[66:67], vcc
    s_waitcnt lgkmcnt(0)
    v_mfma_f32_16x16x32_bf16 v[96:99], v[32:35], v[16:19], 0
    v_mfma_f32_16x16x32_bf16 v[100:103], v[36:39], v[16:19], 0
    v_mfma_f32_16x16x32_bf16 v[104:107], v[40:43], v[16:19], 0
    v_mfma_f32_16x16x32_bf16 v[108:111], v[44:47], v[16:19], 0
    v_mfma_f32_16x16x32_bf16 v[96:99], v[48:51], v[20:23], v[96:99]
    v_mfma_f32_16x16x32_bf16 v[100:103], v[52:55], v[20:23], v[100:103]
    v_mfma_f32_16x16x32_bf16 v[104:107], v[56:59], v[20:23], v[104:107]
    v_mfma_f32_16x16x32_bf16 v[108:111], v[60:63], v[20:23], v[108:111]
    s_nop 7
    s_nop 1
    v_perm_b32 v112, v96, v100, s58
    v_perm_b32 v113, v100, v104, s59
    v_perm_b32 v114, v104, v108, s60
    v_mov_b32 v115, s48
    v_perm_b32 v116, v97, v101, s58
    v_perm_b32 v117, v101, v105, s59
    v_perm_b32 v118, v105, v109, s60
    v_mov_b32 v119, s48
    v_perm_b32 v120, v98, v102, s58
    v_perm_b32 v121, v102, v106, s59
    v_perm_b32 v122, v106, v110, s60
    v_mov_b32 v123, s48
    v_perm_b32 v124, v99, v103, s58
    v_perm_b32 v125, v103, v107, s59
    v_perm_b32 v126, v107, v111, s60
    v_mov_b32 v127, s48
    s_mov_b64 exec, s[66:67]
    global_store_dwordx4 v5, v[112:115], s[56:57] offset:0 sc1
    global_store_dwordx4 v5, v[116:119], s[56:57] offset:128 sc1
    global_store_dwordx4 v5, v[120:123], s[56:57] offset:256 sc1
    global_store_dwordx4 v5, v[124:127], s[56:57] offset:384 sc1
    s_mov_b64 exec, -1
    s_cmp_lg_u32 s3, 0
    s_cbranch_scc1 L_np8c_48
    v_add_u32 v7, 16384, v5
    v_mfma_f32_16x16x32_bf16 v[96:99], v[64:67], v[16:19], 0
    v_mfma_f32_16x16x32_bf16 v[100:103], v[68:71], v[16:19], 0
    v_mfma_f32_16x16x32_bf16 v[104:107], v[72:75], v[16:19], 0
    v_mfma_f32_16x16x32_bf16 v[108:111], v[76:79], v[16:19], 0
    v_mfma_f32_16x16x32_bf16 v[96:99], v[80:83], v[20:23], v[96:99]
    v_mfma_f32_16x16x32_bf16 v[100:103], v[84:87], v[20:23], v[100:103]
    v_mfma_f32_16x16x32_bf16 v[104:107], v[88:91], v[20:23], v[104:107]
    v_mfma_f32_16x16x32_bf16 v[108:111], v[92:95], v[20:23], v[108:111]
    s_nop 7
    s_nop 1
    v_perm_b32 v32, v96, v100, s58
    v_perm_b32 v33, v100, v104, s59
    v_perm_b32 v34, v104, v108, s60
    v_mov_b32 v35, s48
    v_perm_b32 v36, v97, v101, s58
    v_perm_b32 v37, v101, v105, s59
    v_perm_b32 v38, v105, v109, s60
    v_mov_b32 v39, s48
    v_perm_b32 v40, v98, v102, s58
    v_perm_b32 v41, v102, v106, s59
    v_perm_b32 v42, v106, v110, s60
    v_mov_b32 v43, s48
    v_perm_b32 v44, v99, v103, s58
    v_perm_b32 v45, v103, v107, s59
    v_perm_b32 v46, v107, v111, s60
    v_mov_b32 v47, s48
    s_mov_b64 exec, s[66:67]
    global_store_dwordx4 v7, v[32:35], s[56:57] offset:0 sc1
    global_store_dwordx4 v7, v[36:39], s[56:57] offset:128 sc1
    global_store_dwordx4 v7, v[40:43], s[56:57] offset:256 sc1
    global_store_dwordx4 v7, v[44:47], s[56:57] offset:384 sc1
    s_mov_b64 exec, -1
L_np8c_48:
    v_lshrrev_b32 v6, 4, v0
    s_mul_i32 s55, s3, 9
    v_add_u32 v1, s55, v6
    v_mul_u32_u24 v1, 18432, v1
    v_and_b32 v2, 15, v0
    v_lshl_add_u32 v1, v2, 4, v1
    s_lshl_b32 s55, s70, 8
    v_add_u32 v1, s55, v1
    v_add_u32 v3, 73728, v1
    v_mul_u32_u24 v4, 18432, v6
    v_sub_u32 v4, v1, v4
    v_add_u32 v4, 147456, v4
    v_lshrrev_b32 v50, 2, v0
    v_and_b32 v51, 3, v0
    s_lshl_b32 s55, s70, 4
    v_add_u32 v52, s55, v50
    v_and_b32 v53, 7, v52
    v_lshrrev_b32 v54, 3, v52
    v_lshl_add_u32 v54, v54, 2, v51
    v_mul_u32_u24 v55, 576, v53
    v_add_u32 v55, v55, v54
    v_lshlrev_b32 v55, 3, v55
    v_add_u32 v55, 4759552, v55
    s_add_u32 s56, s30, 4849664
    s_addc_u32 s57, s31, 0
    s_mov_b32 s54, 0
L_pl_49:
    global_load_dwordx4 v[16:19], v1, s[56:57] sc1
    global_load_dwordx4 v[20:23], v3, s[56:57] sc1
    global_load_dwordx4 v[24:27], v4, s[56:57] sc1
    s_waitcnt vmcnt(0)
    v_xor_b32 v10, s48, v19
    v_xor_b32 v12, s48, v23
    v_xor_b32 v13, s48, v27
    v_or3_b32 v10, v10, v12, v13
    v_cmp_ne_u32 vcc, 0, v10
    s_add_u32 s54, s54, 1
    s_nop 3
    s_cmp_eq_u64 vcc, 0
    s_cbranch_scc1 L_pld_50
    s_sleep 1
    s_cmp_lt_u32 s54, 400000
    s_cbranch_scc1 L_pl_49
L_pld_50:
    s_mov_b32 s58, 0x0403020c
    s_mov_b32 s59, 0x0504030c
    s_mov_b32 s60, 0xffffff00
    v_and_b32 v32, s60, v16
    v_perm_b32 v33, v16, v17, s58
    v_perm_b32 v34, v17, v18, s59
    v_lshlrev_b32 v35, 8, v18
    v_and_b32 v36, s60, v20
    v_perm_b32 v37, v20, v21, s58
    v_perm_b32 v38, v21, v22, s59
    v_lshlrev_b32 v39, 8, v22
    v_and_b32 v40, s60, v24
    v_perm_b32 v41, v24, v25, s58
    v_perm_b32 v42, v25, v26, s59
    v_lshlrev_b32 v43, 8, v26
    v_add_f32 v32, v32, v36
    v_add_f32 v33, v33, v37
    v_add_f32 v34, v34, v38
    v_add_f32 v35, v35, v39
    v_mov_b32 v44, v32
    v_mov_b32 v45, v33
    v_mov_b32 v46, v34
    v_mov_b32 v47, v35
    s_nop 1
    v_permlane32_swap_b32 v32, v44
    v_permlane32_swap_b32 v33, v45
    v_permlane32_swap_b32 v34, v46
    v_permlane32_swap_b32 v35, v47
    v_add_f32 v32, v32, v44
    v_add_f32 v33, v33, v45
    v_add_f32 v34, v34, v46
    v_add_f32 v35, v35, v47
    v_mov_b32 v44, v32
    v_mov_b32 v45, v33
    v_mov_b32 v46, v34
    v_mov_b32 v47, v35
    s_nop 1
    v_permlane16_swap_b32 v32, v44
    v_permlane16_swap_b32 v33, v45
    v_permlane16_swap_b32 v34, v46
    v_permlane16_swap_b32 v35, v47
    v_add_f32 v32, v32, v44
    v_add_f32 v33, v33, v45
    v_add_f32 v34, v34, v46
    v_add_f32 v35, v35, v47
    v_add_f32 v32, v32, v40
    v_add_f32 v33, v33, v41
    v_add_f32 v34, v34, v42
    v_add_f32 v35, v35, v43
    s_lshl_b32 s55, s3, 8
    v_lshlrev_b32 v5, 4, v2
    v_add_u32 v5, s55, v5
    v_add_u32 v5, 157952, v5
    s_mov_b64 exec, 0xffff
    ds_write_b128 v5, v[32:35]
    s_mov_b64 exec, -1
    s_waitcnt lgkmcnt(0)
    s_barrier
    s_cmp_lg_u32 s3, 0
    s_cbranch_scc1 L_nofin_51
    v_lshlrev_b32 v6, 4, v50
    v_lshl_add_u32 v6, v51, 2, v6
    v_add_u32 v6, 157952, v6
    ds_read_b32 v16, v6 offset:0
    ds_read_b32 v17, v6 offset:256
    ds_read_b32 v18, v6 offset:512
    ds_read_b32 v19, v6 offset:768
    ds_read_b32 v20, v6 offset:1024
    ds_read_b32 v21, v6 offset:1280
    ds_read_b32 v22, v6 offset:1536
    ds_read_b32 v23, v6 offset:1792
    v_mul_u32_u24 v7, 1168, v53
    v_lshl_add_u32 v7, v54, 1, v7
    v_add_u32 v7, 147456, v7
    ds_read_u16 v24, v7
    v_lshlrev_b32 v8, 2, v53
    v_add_u32 v8, 162048, v8
    ds_read_b32 v25, v8 offset:32
    ds_read_b32 v26, v8 offset:64
    v_mov_b32 v5, v54
    s_waitcnt lgkmcnt(0)
    v_add_f32 v16, v16, v17
    v_add_f32 v18, v18, v19
    v_add_f32 v20, v20, v21
    v_add_f32 v22, v22, v23
    v_add_f32 v16, v16, v18
    v_add_f32 v20, v20, v22
    v_add_f32 v16, v16, v20
    v_cvt_pk_bf16_f32 v16, 0, v16
    v_mul_f32 v16, v16, v26
    v_cvt_pk_bf16_f32 v16, 0, v16
    v_lshlrev_b32 v24, 16, v24
    v_add_f32 v16, v24, v16
    v_cvt_pk_bf16_f32 v16, 0, v16
    v_and_b32 v25, 0x7ff, v25
    v_xor_b32 v25, 0x7ff, v25
    v_mul_u32_u24 v25, 1152, v25
    v_lshl_add_u32 v25, v5, 1, v25
    s_mov_b32 s54, 0
L_pl_52:
    global_load_dwordx2 v[28:29], v55, s[30:31] sc1
    s_waitcnt vmcnt(0)
    v_xor_b32 v10, s48, v29
    v_cmp_ne_u32 vcc, 0, v10
    s_add_u32 s54, s54, 1
    s_nop 3
    s_cmp_eq_u64 vcc, 0
    s_cbranch_scc1 L_pld_53
    s_cmp_lt_u32 s54, 400000
    s_cbranch_scc1 L_pl_52
L_pld_53:
    v_add_f32 v16, v28, v16
    v_cvt_pk_bf16_f32 v16, v16, v16
    global_store_short v25, v16, s[26:27]
L_nofin_51:
    s_branch L_fin
L_spare:
    s_sub_u32 s69, s69, 72
    s_mul_i32 s68, s69, 24
    s_lshl_b32 s55, s3, 2
    s_add_u32 s68, s68, s55
    s_add_u32 s68, s68, 1152
    s_cmp_ge_u32 s3, 6
    s_cbranch_scc1 L_lne_54
    s_cmp_ge_u32 s68, 2048
    s_cbranch_scc1 L_lne_54
    s_mov_b32 s54, s68
    v_lshrrev_b32 v1, 4, v0
    v_and_b32 v2, 15, v0
    v_add_u32 v3, s54, v1
    v_mul_u32_u24 v4, 1152, v3
    v_lshl_add_u32 v5, v2, 4, v4
    v_lshl_add_u32 v6, v2, 3, v4
    global_load_dwordx4 v[10:13], v5, s[4:5] offset:0
    global_load_dwordx4 v[14:17], v5, s[4:5] offset:256
    global_load_dwordx4 v[18:21], v5, s[4:5] offset:512
    global_load_dwordx4 v[22:25], v5, s[4:5] offset:768
    global_load_dwordx2 v[26:27], v6, s[4:5] offset:1024
    v_lshlrev_b32 v7, 4, v2
    v_lshlrev_b32 v8, 3, v2
    global_load_dwordx4 v[28:31], v7, s[18:19] offset:0
    global_load_dwordx4 v[32:35], v7, s[18:19] offset:256
    global_load_dwordx4 v[36:39], v7, s[18:19] offset:512
    global_load_dwordx4 v[40:43], v7, s[18:19] offset:768
    global_load_dwordx2 v[44:45], v8, s[18:19] offset:1024
    v_mov_b32 v120, 0
    global_load_dword v121, v120, s[28:29] sc1
    s_waitcnt vmcnt(1)
    s_mov_b32 s62, 0x3f803f80
    s_mov_b32 s63, 0x00003f80
    s_mov_b32 s64, 0x3f800000
    v_mov_b32 v64, 0
    v_mov_b32 v65, 0
    v_mov_b32 v66, 0
    v_mov_b32 v67, 0
    v_mov_b32 v68, 0
    v_mov_b32 v69, 0
    v_dot2_f32_bf16 v64, v10, s62, v64
    v_dot2_f32_bf16 v66, v10, v28, v66
    v_dot2_f32_bf16 v68, v28, s62, v68
    v_dot2_f32_bf16 v65, v11, s62, v65
    v_dot2_f32_bf16 v67, v11, v29, v67
    v_dot2_f32_bf16 v69, v29, s62, v69
    v_dot2_f32_bf16 v64, v12, s62, v64
    v_dot2_f32_bf16 v66, v12, v30, v66
    v_dot2_f32_bf16 v68, v30, s62, v68
    v_dot2_f32_bf16 v65, v13, s62, v65
    v_dot2_f32_bf16 v67, v13, v31, v67
    v_dot2_f32_bf16 v69, v31, s62, v69
    v_dot2_f32_bf16 v64, v14, s62, v64
    v_dot2_f32_bf16 v66, v14, v32, v66
    v_dot2_f32_bf16 v68, v32, s62, v68
    v_dot2_f32_bf16 v65, v15, s62, v65
    v_dot2_f32_bf16 v67, v15, v33, v67
    v_dot2_f32_bf16 v69, v33, s62, v69
    v_dot2_f32_bf16 v64, v16, s62, v64
    v_dot2_f32_bf16 v66, v16, v34, v66
    v_dot2_f32_bf16 v68, v34, s62, v68
    v_dot2_f32_bf16 v65, v17, s62, v65
    v_dot2_f32_bf16 v67, v17, v35, v67
    v_dot2_f32_bf16 v69, v35, s62, v69
    v_dot2_f32_bf16 v64, v18, s62, v64
    v_dot2_f32_bf16 v66, v18, v36, v66
    v_dot2_f32_bf16 v68, v36, s62, v68
    v_dot2_f32_bf16 v65, v19, s62, v65
    v_dot2_f32_bf16 v67, v19, v37, v67
    v_dot2_f32_bf16 v69, v37, s62, v69
    v_dot2_f32_bf16 v64, v20, s62, v64
    v_dot2_f32_bf16 v66, v20, v38, v66
    v_dot2_f32_bf16 v68, v38, s62, v68
    v_dot2_f32_bf16 v65, v21, s62, v65
    v_dot2_f32_bf16 v67, v21, v39, v67
    v_dot2_f32_bf16 v69, v39, s62, v69
    v_dot2_f32_bf16 v64, v22, s62, v64
    v_dot2_f32_bf16 v66, v22, v40, v66
    v_dot2_f32_bf16 v68, v40, s62, v68
    v_dot2_f32_bf16 v65, v23, s62, v65
    v_dot2_f32_bf16 v67, v23, v41, v67
    v_dot2_f32_bf16 v69, v41, s62, v69
    v_dot2_f32_bf16 v64, v24, s62, v64
    v_dot2_f32_bf16 v66, v24, v42, v66
    v_dot2_f32_bf16 v68, v42, s62, v68
    v_dot2_f32_bf16 v65, v25, s62, v65
    v_dot2_f32_bf16 v67, v25, v43, v67
    v_dot2_f32_bf16 v69, v43, s62, v69
    v_dot2_f32_bf16 v64, v26, s62, v64
    v_dot2_f32_bf16 v66, v26, v44, v66
    v_dot2_f32_bf16 v68, v44, s62, v68
    v_dot2_f32_bf16 v65, v27, s62, v65
    v_dot2_f32_bf16 v67, v27, v45, v67
    v_dot2_f32_bf16 v69, v45, s62, v69
    s_nop 2
    v_add_f32 v64, v64, v65
    v_add_f32 v66, v66, v67
    v_add_f32 v122, v68, v69
    s_nop 0
    v_add_f32_dpp v64, v64, v64 row_ror:8 row_mask:0xf bank_mask:0xf
    v_add_f32_dpp v66, v66, v66 row_ror:8 row_mask:0xf bank_mask:0xf
    v_add_f32_dpp v122, v122, v122 row_ror:8 row_mask:0xf bank_mask:0xf
    v_add_f32_dpp v64, v64, v64 row_ror:4 row_mask:0xf bank_mask:0xf
    v_add_f32_dpp v66, v66, v66 row_ror:4 row_mask:0xf bank_mask:0xf
    v_add_f32_dpp v122, v122, v122 row_ror:4 row_mask:0xf bank_mask:0xf
    v_add_f32_dpp v64, v64, v64 row_ror:2 row_mask:0xf bank_mask:0xf
    v_add_f32_dpp v66, v66, v66 row_ror:2 row_mask:0xf bank_mask:0xf
    v_add_f32_dpp v122, v122, v122 row_ror:2 row_mask:0xf bank_mask:0xf
    v_add_f32_dpp v64, v64, v64 row_ror:1 row_mask:0xf bank_mask:0xf
    v_add_f32_dpp v66, v66, v66 row_ror:1 row_mask:0xf bank_mask:0xf
    v_add_f32_dpp v122, v122, v122 row_ror:1 row_mask:0xf bank_mask:0xf
    v_mul_f32 v64, 0x3ae38e39, v64
    v_sub_f32 v65, 0, v64
    v_mov_b32 v68, 0
    v_mov_b32 v69, 0
    v_mov_b32 v70, 0
    v_mov_b32 v71, 0
    v_dot2_f32_bf16 v72, v10, s63, v65
    v_dot2_f32_bf16 v73, v10, s64, v65
    v_dot2_f32_bf16 v74, v11, s63, v65
    v_dot2_f32_bf16 v75, v11, s64, v65
    s_nop 1
    v_fma_f32 v68, v72, v72, v68
    v_fma_f32 v69, v73, v73, v69
    v_fma_f32 v70, v74, v74, v70
    v_fma_f32 v71, v75, v75, v71
    v_dot2_f32_bf16 v72, v12, s63, v65
    v_dot2_f32_bf16 v73, v12, s64, v65
    v_dot2_f32_bf16 v74, v13, s63, v65
    v_dot2_f32_bf16 v75, v13, s64, v65
    s_nop 1
    v_fma_f32 v68, v72, v72, v68
    v_fma_f32 v69, v73, v73, v69
    v_fma_f32 v70, v74, v74, v70
    v_fma_f32 v71, v75, v75, v71
    v_dot2_f32_bf16 v72, v14, s63, v65
    v_dot2_f32_bf16 v73, v14, s64, v65
    v_dot2_f32_bf16 v74, v15, s63, v65
    v_dot2_f32_bf16 v75, v15, s64, v65
    s_nop 1
    v_fma_f32 v68, v72, v72, v68
    v_fma_f32 v69, v73, v73, v69
    v_fma_f32 v70, v74, v74, v70
    v_fma_f32 v71, v75, v75, v71
    v_dot2_f32_bf16 v72, v16, s63, v65
    v_dot2_f32_bf16 v73, v16, s64, v65
    v_dot2_f32_bf16 v74, v17, s63, v65
    v_dot2_f32_bf16 v75, v17, s64, v65
    s_nop 1
    v_fma_f32 v68, v72, v72, v68
    v_fma_f32 v69, v73, v73, v69
    v_fma_f32 v70, v74, v74, v70
    v_fma_f32 v71, v75, v75, v71
    v_dot2_f32_bf16 v72, v18, s63, v65
    v_dot2_f32_bf16 v73, v18, s64, v65
    v_dot2_f32_bf16 v74, v19, s63, v65
    v_dot2_f32_bf16 v75, v19, s64, v65
    s_nop 1
    v_fma_f32 v68, v72, v72, v68
    v_fma_f32 v69, v73, v73, v69
    v_fma_f32 v70, v74, v74, v70
    v_fma_f32 v71, v75, v75, v71
    v_dot2_f32_bf16 v72, v20, s63, v65
    v_dot2_f32_bf16 v73, v20, s64, v65
    v_dot2_f32_bf16 v74, v21, s63, v65
    v_dot2_f32_bf16 v75, v21, s64, v65
    s_nop 1
    v_fma_f32 v68, v72, v72, v68
    v_fma_f32 v69, v73, v73, v69
    v_fma_f32 v70, v74, v74, v70
    v_fma_f32 v71, v75, v75, v71
    v_dot2_f32_bf16 v72, v22, s63, v65
    v_dot2_f32_bf16 v73, v22, s64, v65
    v_dot2_f32_bf16 v74, v23, s63, v65
    v_dot2_f32_bf16 v75, v23, s64, v65
    s_nop 1
    v_fma_f32 v68, v72, v72, v68
    v_fma_f32 v69, v73, v73, v69
    v_fma_f32 v70, v74, v74, v70
    v_fma_f32 v71, v75, v75, v71
    v_dot2_f32_bf16 v72, v24, s63, v65
    v_dot2_f32_bf16 v73, v24, s64, v65
    v_dot2_f32_bf16 v74, v25, s63, v65
    v_dot2_f32_bf16 v75, v25, s64, v65
    s_nop 1
    v_fma_f32 v68, v72, v72, v68
    v_fma_f32 v69, v73, v73, v69
    v_fma_f32 v70, v74, v74, v70
    v_fma_f32 v71, v75, v75, v71
    v_dot2_f32_bf16 v72, v26, s63, v65
    v_dot2_f32_bf16 v73, v26, s64, v65
    v_dot2_f32_bf16 v74, v27, s63, v65
    v_dot2_f32_bf16 v75, v27, s64, v65
    s_nop 1
    v_fma_f32 v68, v72, v72, v68
    v_fma_f32 v69, v73, v73, v69
    v_fma_f32 v70, v74, v74, v70
    v_fma_f32 v71, v75, v75, v71
    v_add_f32 v68, v68, v69
    v_add_f32 v70, v70, v71
    v_add_f32 v68, v68, v70
    s_nop 1
    v_add_f32_dpp v68, v68, v68 row_ror:8 row_mask:0xf bank_mask:0xf
    s_nop 1
    v_add_f32_dpp v68, v68, v68 row_ror:4 row_mask:0xf bank_mask:0xf
    s_nop 1
    v_add_f32_dpp v68, v68, v68 row_ror:2 row_mask:0xf bank_mask:0xf
    s_nop 1
    v_add_f32_dpp v68, v68, v68 row_ror:1 row_mask:0xf bank_mask:0xf
    v_mul_f32 v68, 0x3ae38e39, v68
    v_cvt_pk_bf16_f32 v68, 0, v68
    v_add_f32 v68, 0x3727c5ac, v68
    v_cvt_pk_bf16_f32 v68, 0, v68
    v_sqrt_f32 v69, v68
    s_nop 0
    v_rcp_f32 v70, v69
    v_fma_f32 v71, -v69, v69, v68
    v_mul_f32 v70, 0.5, v70
    v_fma_f32 v69, v71, v70, v69
    v_cvt_pk_bf16_f32 v69, 0, v69
    v_rcp_f32 v70, v69
    v_cvt_pk_bf16_f32 v64, 0, v64
    v_fma_f32 v66, -v64, v122, v66
    v_mul_f32 v112, v66, v70
    v_cvt_pk_bf16_f32 v112, 0, v112
    v_xor_b32 v113, 0x7ff, v3
    v_or_b32 v112, v112, v113
    v_cvt_pk_bf16_f32 v114, v64, v69
    s_waitcnt vmcnt(0)
    v_readfirstlane_b32 s48, v121
    s_cmp_lg_u32 s48, 0
    s_cbranch_scc1 L_lnn_55
    v_mov_b32 v124, 0
    s_mov_b32 s54, 0
L_nonce_56:
    global_load_dword v125, v124, s[28:29] sc1
    s_waitcnt vmcnt(0)
    v_readfirstlane_b32 s48, v125
    s_add_u32 s54, s54, 1
    s_cmp_lg_u32 s48, 0
    s_cbranch_scc1 L_nonced_57
    s_cmp_lt_u32 s54, 400000
    s_cbranch_scc1 L_nonce_56
L_nonced_57:
L_lnn_55:
    v_mov_b32 v113, s48
    v_mov_b32 v115, s48
    v_lshlrev_b32 v116, 3, v3
    s_add_u32 s56, s30, 4718592
    s_addc_u32 s57, s31, 0
    s_add_u32 s58, s30, 4734976
    s_addc_u32 s59, s31, 0
    v_cmp_eq_u32 vcc, 0, v2
    s_and_saveexec_b64 s[60:61], vcc
    global_store_dwordx2 v116, v[112:113], s[56:57] sc1
    global_store_dwordx2 v116, v[114:115], s[58:59] sc1
    s_mov_b64 exec, s[60:61]
L_lne_54:
    s_cmp_lg_u32 s69, 39
    s_cbranch_scc1 L_fin
    s_lshl_b32 s55, s3, 10
    v_lshlrev_b32 v110, 4, v0
    v_add_u32 v111, s55, v110
    v_add_u32 v111, 0, v111
    v_mov_b32 v112, 0xff800000
    v_mov_b32 v113, 0xff800000
    v_mov_b32 v114, 0xff800000
    v_mov_b32 v115, 0xff800000
    ds_write_b128 v111, v[112:115]
    s_cmp_lg_u32 s3, 0
    s_cbranch_scc1 L_ni_58
    v_add_u32 v111, 8192, v110
    s_mov_b64 exec, 0xf
    ds_write_b128 v111, v[112:115]
    s_mov_b64 exec, -1
    v_mov_b32 v116, 0
    v_mov_b32 v117, 0
    v_mov_b32 v118, 0
    v_mov_b32 v119, 0
    v_add_u32 v111, 162048, v110
    s_mov_b64 exec, 0x3ff
    ds_write_b128 v111, v[116:119]
    s_mov_b64 exec, -1
L_ni_58:
    v_mov_b32 v124, 0
    s_mov_b32 s54, 0
L_nonce_59:
    global_load_dword v125, v124, s[28:29] sc1
    s_waitcnt vmcnt(0)
    v_readfirstlane_b32 s48, v125
    s_add_u32 s54, s54, 1
    s_cmp_lg_u32 s48, 0
    s_cbranch_scc1 L_nonced_60
    s_cmp_lt_u32 s54, 400000
    s_cbranch_scc1 L_nonce_59
L_nonced_60:
    s_waitcnt lgkmcnt(0)
    s_barrier
    s_lshl_b32 s55, s3, 6
    v_add_u32 v1, s55, v0
    v_lshlrev_b32 v2, 5, v1
    s_add_u32 s56, s30, 4718592
    s_addc_u32 s57, s31, 0
    s_mov_b32 s54, 0
L_pl_61:
    global_load_dwordx4 v[16:19], v2, s[56:57] offset:0 sc1
    global_load_dwordx4 v[20:23], v2, s[56:57] offset:16 sc1
    s_waitcnt vmcnt(0)
    v_xor_b32 v10, s48, v17
    v_xor_b32 v12, s48, v19
    v_xor_b32 v13, s48, v21
    v_or3_b32 v10, v10, v12, v13
    v_xor_b32 v12, s48, v23
    v_or_b32 v10, v10, v12
    v_cmp_ne_u32 vcc, 0, v10
    s_add_u32 s54, s54, 1
    s_nop 3
    s_cmp_eq_u64 vcc, 0
    s_cbranch_scc1 L_pld_62
    s_sleep 1
    s_cmp_lt_u32 s54, 400000
    s_cbranch_scc1 L_pl_61
L_pld_62:
    v_max3_f32 v40, v16, v18, v20
    v_max_f32 v40, v40, v22
    s_nop 1
    v_max_f32_dpp v40, v40, v40 row_ror:8 row_mask:0xf bank_mask:0xf
    s_nop 1
    v_max_f32_dpp v40, v40, v40 row_ror:4 row_mask:0xf bank_mask:0xf
    s_nop 1
    v_max_f32_dpp v40, v40, v40 row_ror:2 row_mask:0xf bank_mask:0xf
    s_nop 1
    v_max_f32_dpp v40, v40, v40 row_ror:1 row_mask:0xf bank_mask:0xf
    s_nop 1
    v_readlane_b32 s58, v40, 16
    v_readlane_b32 s59, v40, 32
    v_readlane_b32 s60, v40, 48
    s_nop 1
    v_max_f32 v40, s58, v40
    v_max_f32 v40, s59, v40
    v_max_f32 v40, s60, v40
    s_lshl_b32 s58, s3, 2
    s_add_u32 s58, s58, 162144
    v_mov_b32 v43, s58
    s_mov_b64 exec, 1
    ds_write_b32 v43, v40
    s_mov_b64 exec, -1
    s_waitcnt lgkmcnt(0)
    s_barrier
    v_mov_b32 v43, 162144
    ds_read_b128 v[44:47], v43
    ds_read_b128 v[48:51], v43 offset:16
    s_waitcnt lgkmcnt(0)
    v_min3_f32 v40, v44, v45, v46
    v_min3_f32 v41, v47, v48, v49
    v_min3_f32 v40, v40, v50, v51
    v_min_f32 v40, v40, v41
    v_mov_b32 v41, 0
    v_cmp_ge_f32 s[58:59], v16, v40
    v_cmp_ge_f32 s[60:61], v18, v40
    v_cmp_ge_f32 s[62:63], v20, v40
    v_cmp_ge_f32 s[64:65], v22, v40
    v_addc_co_u32 v41, vcc, 0, v41, s[58:59]
    v_addc_co_u32 v41, vcc, 0, v41, s[60:61]
    v_addc_co_u32 v41, vcc, 0, v41, s[62:63]
    v_addc_co_u32 v41, vcc, 0, v41, s[64:65]
    v_mov_b32 v43, 162048
    v_cmp_lt_u32 vcc, 0, v41
    s_and_saveexec_b64 s[66:67], vcc
    ds_add_rtn_u32 v42, v43, v41
    s_mov_b64 exec, s[66:67]
    s_waitcnt lgkmcnt(0)
    v_lshlrev_b32 v42, 2, v42
    v_add_u32 v42, 0, v42
    v_mov_b32 v43, 16384
    v_cndmask_b32 v44, v43, v42, s[58:59]
    v_cndmask_b32 v45, 0, 4, s[58:59]
    ds_write_b32 v44, v16
    v_add_u32 v42, v42, v45
    v_cndmask_b32 v44, v43, v42, s[60:61]
    v_cndmask_b32 v45, 0, 4, s[60:61]
    ds_write_b32 v44, v18
    v_add_u32 v42, v42, v45
    v_cndmask_b32 v44, v43, v42, s[62:63]
    v_cndmask_b32 v45, 0, 4, s[62:63]
    ds_write_b32 v44, v20
    v_add_u32 v42, v42, v45
    v_cndmask_b32 v44, v43, v42, s[64:65]
    v_cndmask_b32 v45, 0, 4, s[64:65]
    ds_write_b32 v44, v22
    v_add_u32 v42, v42, v45
    s_waitcnt lgkmcnt(0)
    s_barrier
    v_mov_b32 v43, 162048
    ds_read_b32 v44, v43
    s_waitcnt lgkmcnt(0)
    v_readfirstlane_b32 s62, v44
    s_mov_b32 s63, 0
L_chunk_63:
    v_add_u32 v44, s63, v0
    v_lshlrev_b32 v44, 2, v44
    v_add_u32 v44, 0, v44
    ds_read_b32 v46, v44
    v_mov_b32 v47, 0
    v_mov_b32 v45, 0
    s_mov_b32 s64, 0
L_j_64:
    ds_read_b128 v[48:51], v45
    ds_read_b128 v[52:55], v45 offset:16
    v_add_u32 v45, 32, v45
    s_add_u32 s64, s64, 8
    s_waitcnt lgkmcnt(1)
    v_cmp_gt_f32 s[54:55], v48, v46
    v_cmp_gt_f32 s[56:57], v49, v46
    v_cmp_gt_f32 s[58:59], v50, v46
    v_cmp_gt_f32 s[60:61], v51, v46
    v_addc_co_u32 v47, vcc, 0, v47, s[54:55]
    v_addc_co_u32 v47, vcc, 0, v47, s[56:57]
    v_addc_co_u32 v47, vcc, 0, v47, s[58:59]
    v_addc_co_u32 v47, vcc, 0, v47, s[60:61]
    s_waitcnt lgkmcnt(0)
    v_cmp_gt_f32 s[54:55], v52, v46
    v_cmp_gt_f32 s[56:57], v53, v46
    v_cmp_gt_f32 s[58:59], v54, v46
    v_cmp_gt_f32 s[60:61], v55, v46
    v_addc_co_u32 v47, vcc, 0, v47, s[54:55]
    v_addc_co_u32 v47, vcc, 0, v47, s[56:57]
    v_addc_co_u32 v47, vcc, 0, v47, s[58:59]
    v_addc_co_u32 v47, vcc, 0, v47, s[60:61]
    s_cmp_lt_u32 s64, s62
    s_cbranch_scc1 L_j_64
    v_add_u32 v44, s63, v0
    v_cmp_gt_u32 vcc, s62, v44
    v_cmp_gt_u32 s[54:55], 8, v47
    s_nop 1
    s_and_b64 vcc, vcc, s[54:55]
    s_and_saveexec_b64 s[66:67], vcc
    v_lshlrev_b32 v47, 2, v47
    v_add_u32 v47, 162080, v47
    ds_write_b32 v47, v46
    s_mov_b64 exec, s[66:67]
    s_add_u32 s63, s63, 64
    s_cmp_lt_u32 s63, s62
    s_cbranch_scc1 L_chunk_63
    s_waitcnt lgkmcnt(0)
    s_cmp_lg_u32 s3, 0
    s_cbranch_scc1 L_sp_65
    v_lshlrev_b32 v1, 2, v0
    v_add_u32 v1, 162080, v1
    s_mov_b64 exec, 0xff
    ds_read_b32 v2, v1
    s_add_u32 s56, s30, 4757504
    s_addc_u32 s57, s31, 0
    v_mov_b32 v3, s48
    v_lshlrev_b32 v4, 3, v0
    s_waitcnt lgkmcnt(0)
    global_store_dwordx2 v4, v[2:3], s[56:57] sc1
    s_mov_b64 exec, -1
L_sp_65:
    s_branch L_fin
L_fin:
L_end:
    s_endpgm
.section .rodata,"a"
.p2align 6
.amdhsa_kernel parallel_sum__ssm_conv_h3__moe_arch_mod__prompt_kernel
  .amdhsa_next_free_vgpr 256
  .amdhsa_next_free_sgpr 102
  .amdhsa_accum_offset 192
  .amdhsa_group_segment_fixed_size 0
  .amdhsa_kernarg_size 112
  .amdhsa_user_sgpr_count 2
  .amdhsa_user_sgpr_kernarg_segment_ptr 1
  .amdhsa_system_sgpr_workgroup_id_x 1
  .amdhsa_float_denorm_mode_32 3
.end_amdhsa_kernel
.text
```
